```python
import torch

def _softmax(x, axis=-1):
    return torch.softmax(x, dim=axis)

def _gelu(x):
    return torch.nn.functional.gelu(x, approximate='tanh')

def _silu(x):
    return torch.nn.functional.silu(x)

def _sigmoid(x):
    return torch.sigmoid(x)

def _layernorm(x, axis=-1, eps=1e-05):
    m = x.mean(dim=axis, keepdim=True)
    v = x.var(dim=axis, keepdim=True, unbiased=False)
    return (x - m) / torch.sqrt(v + eps)

def _scatter_add(tgt, idx, src, axis=0):
    return tgt.clone().index_add_(axis, idx, src)

def _segment_sum(src, seg, n):
    out = torch.zeros((n,) + src.shape[1:], dtype=src.dtype)
    return out.index_add_(0, seg, src)

def _pad(x, pw):
    flat = tuple((v for pair in reversed(pw) for v in pair))
    return torch.nn.functional.pad(x, flat)
kernel_name = 'adaLN_cond__mha_block__glu_gated_glu__prompt'

def setup_inputs():

    _w = lambda a: (lambda t: t.to(torch.bfloat16) if t.is_floating_point() else t)(torch.as_tensor(a))

    def _A_setup():
        B, S, D, H = (1, 2048, 640, 32)
        return {'x': _w((lambda *s: torch.randn(*s, dtype=torch.bfloat16) * 0.05)(B, S, D)), 'wqkv': _w((lambda *s: torch.randn(*s, dtype=torch.bfloat16) * 0.05)(D, 3 * D)), 'wo': _w((lambda *s: torch.randn(*s, dtype=torch.bfloat16) * 0.05)(D, D))}
    _A_in = _A_setup()

    def _B_setup():
        B, S, D, F = (1, 2048, 640, 1728)
        return {'x': _w((lambda *s: torch.randn(*s, dtype=torch.bfloat16) * 0.05)(B, S, D)), 'w_gate': _w((lambda *s: torch.randn(*s, dtype=torch.bfloat16) * 0.05)(D, F)), 'w_up': _w((lambda *s: torch.randn(*s, dtype=torch.bfloat16) * 0.05)(D, F)), 'w_down': _w((lambda *s: torch.randn(*s, dtype=torch.bfloat16) * 0.05)(F, D))}
    _B_in = _B_setup()
    return {'A_x': _A_in['x'], 'A_wqkv': _A_in['wqkv'], 'A_wo': _A_in['wo'], 'B_x': _B_in['x'], 'B_w_gate': _B_in['w_gate'], 'B_w_up': _B_in['w_up'], 'B_w_down': _B_in['w_down'], 'c': _w((lambda *s: torch.randn(*s, dtype=torch.bfloat16) * 0.2)(1, 640) * 8.0), 'w_mod': _w((lambda *s: torch.randn(*s, dtype=torch.bfloat16) * 0.2)(640, 6 * 640) * 640 ** (-0.5) * 8.0)}

def reference(A_x, A_wqkv, A_wo, B_x, B_w_gate, B_w_up, B_w_down, c, w_mod):

    def _A_ref(x, wqkv, wo):
        B, S, D = x.shape
        H = 32
        Dh = D // H
        qkv = (lambda x, *d: x.permute(*d))((x @ wqkv).reshape(B, S, 3, H, Dh), 2, 0, 3, 1, 4)
        q, k, v = (qkv[0], qkv[1], qkv[2])
        scores = torch.einsum('bhqd,bhkd->bhqk', q, k) * Dh ** (-0.5)
        p = _softmax(scores, axis=-1)
        o = torch.einsum('bhqk,bhkd->bhqd', p, v)
        return (lambda x, *d: x.permute(*d))(o, 0, 2, 1, 3).reshape(B, S, D) @ wo

    def _B_ref(x, w_gate, w_up, w_down):
        g = torch.einsum('bsd,df->bsf', x, w_gate)
        u = torch.einsum('bsd,df->bsf', x, w_up)
        h = _sigmoid(g) * u
        return torch.einsum('bsf,fd->bsd', h, w_down)
    x = A_x
    mod = (_silu(c) @ w_mod).reshape(c.shape[0], 6, 1, -1)
    sa, ca, ga, sb, cb, gb = (mod[:, 0].clone(), mod[:, 1].clone(), mod[:, 2].clone(), mod[:, 3].clone(), mod[:, 4].clone(), mod[:, 5].clone())
    h = _layernorm(x, axis=-1) * (1 + ca) + sa
    x = x + ga * _A_ref(h, A_wqkv, A_wo)
    h = _layernorm(x, axis=-1) * (1 + cb) + sb
    x = x + gb * _B_ref(h, B_w_gate, B_w_up, B_w_down)
    return x
```

```asm
; @launch grid=(256,1,1) block=(512,1,1) lds=163840
.amdgcn_target "amdgcn-amd-amdhsa--gfx950"
.text
.globl adaLN_cond__mha_block__glu_gated_glu__prompt_kernel
.p2align 8
.type adaLN_cond__mha_block__glu_gated_glu__prompt_kernel,@function
adaLN_cond__mha_block__glu_gated_glu__prompt_kernel:
    s_cmp_ge_u32 s2, 256
    s_cbranch_scc1 L_end_adaLN_cond__mha_block__glu_gated_glu__prompt_kernel
    s_load_dwordx2 s[4:5], s[0:1], 88
    s_getpc_b64 s[98:99]
    v_lshlrev_b32 v1, 4, v0
    global_load_dwordx4 v[248:251], v1, s[98:99]
    v_lshrrev_b32 v1, 6, v0
    s_nop 0
    v_readfirstlane_b32 s10, v1
    v_and_b32 v1, 63, v0
    s_mov_b32 s6, 268435456
    s_mov_b32 s7, 0x20000
    s_load_dwordx2 s[12:13], s[0:1], 0
    s_load_dwordx2 s[16:17], s[0:1], 72
    s_mov_b32 s18, 2621440
    s_mov_b32 s19, 0x20000
    s_load_dwordx4 s[68:71], s[0:1], 56
    s_load_dwordx2 s[72:73], s[0:1], 8
    v_mov_b32 v24, 158720
    v_mov_b32 v26, 0
    v_mov_b32 v27, 0
    ds_write_b64 v24, v[26:27]
    ds_write_b32 v24, v26 offset:8
    s_bfe_u32 s76, s2, 0x20001
    s_lshl_b32 s76, s76, 3
    s_lshr_b32 s78, s2, 5
    s_add_u32 s76, s76, s78
    s_and_b32 s77, s2, 1
    s_lshl_b32 s77, s77, 2
    s_bfe_u32 s78, s2, 0x20003
    s_add_u32 s77, s77, s78
    v_lshrrev_b32 v15, 3, v1
    v_and_b32 v16, 7, v1
    v_mul_u32_u24 v230, 1280, v15
    v_lshl_add_u32 v230, v16, 4, v230
    v_lshlrev_b32 v20, 4, v1
    s_mul_i32 s78, s76, 81920
    s_lshl_b32 s79, s10, 7
    s_add_u32 s83, s78, s79
    s_lshr_b32 s85, s10, 2
    s_add_u32 s85, s85, 8
    s_and_b32 s86, s10, 3
    s_lshl_b32 s86, s86, 1
    s_mul_i32 s84, s86, 10240
    s_add_u32 s84, s84, s78
    s_lshl_b32 s79, s85, 7
    s_add_u32 s84, s84, s79
    s_waitcnt lgkmcnt(0)
    s_load_dword s21, s[4:5], 0
    s_barrier
    s_mov_b32 s14, 2621440
    s_mov_b32 s15, 0x20000
    s_mov_b32 s91, 3
    s_cmp_eq_u32 s10, 7
    s_cbranch_scc1 L_p0_const_234007
    s_cmp_ge_u32 s10, 5
    s_cbranch_scc1 L_p0_pack_234006
    s_cmp_eq_u32 s10, 4
    s_cbranch_scc1 L_p0_x_234008
    s_mov_b32 s72, s70
    s_mov_b32 s73, s71
    s_mov_b32 s74, 4915200
    s_mov_b32 s75, 0x20000
    s_mov_b32 s70, 1280
    s_mov_b32 s71, 0x20000
    s_cmp_ge_u32 s2, 240
    s_cbranch_scc1 L_p0_x_234008
    s_mov_b32 s91, 3
    s_cmp_ge_u32 s2, 240
    s_cbranch_scc1 L_p0_x_234008
    s_and_b32 s78, s2, 3
    s_mul_i32 s78, s78, 160
    s_mul_i32 s79, s10, 40
    s_add_u32 s78, s78, s79
    v_lshrrev_b32 v63, 3, v1
    v_add_u32 v63, s78, v63
    v_mul_u32_u24 v64, 7680, v63
    v_and_b32 v58, 7, v1
    v_lshl_add_u32 v64, v58, 4, v64
    v_lshlrev_b32 v63, 1, v63
    s_lshr_b32 s87, s2, 2
    s_lshl_b32 s87, s87, 7
    buffer_load_ushort v58, v63, s[68:71], 0 offen offset:0
    buffer_load_ushort v59, v63, s[68:71], 0 offen offset:16
    buffer_load_ushort v60, v63, s[68:71], 0 offen offset:32
    buffer_load_ushort v61, v63, s[68:71], 0 offen offset:48
    buffer_load_ushort v62, v63, s[68:71], 0 offen offset:64
    buffer_load_dwordx4 v[38:41], v64, s[72:75], s87 offen
    s_add_u32 s87, s87, 61440
    buffer_load_dwordx4 v[42:45], v64, s[72:75], s87 offen
    s_add_u32 s87, s87, 61440
    buffer_load_dwordx4 v[46:49], v64, s[72:75], s87 offen
    s_add_u32 s87, s87, 61440
    buffer_load_dwordx4 v[50:53], v64, s[72:75], s87 offen
    s_add_u32 s87, s87, 61440
    buffer_load_dwordx4 v[54:57], v64, s[72:75], s87 offen
    v_lshrrev_b32 v76, 3, v1
    v_lshlrev_b32 v76, 7, v76
    v_add_u32 v76, v76, v20
    s_mul_i32 s78, s2, 10240
    s_min_u32 s78, s78, 665600
    s_add_u32 s78, s78, 131072
    s_cmp_ge_u32 s2, 80
    s_cselect_b32 s78, 0x40000000, s78
    s_cmp_lg_u32 s10, 0
    s_cselect_b32 s78, 0x40000000, s78
    v_mov_b32 v72, 0
    v_mov_b32 v73, 0
    v_mov_b32 v74, 0
    v_mov_b32 v75, 0
    buffer_store_dwordx4 v[72:75], v76, s[4:7], s78 offen offset:0 sc1
    buffer_store_dwordx4 v[72:75], v76, s[4:7], s78 offen offset:2048 sc1
    s_add_u32 s78, s78, 4096
    buffer_store_dwordx4 v[72:75], v76, s[4:7], s78 offen offset:0 sc1
    buffer_store_dwordx4 v[72:75], v76, s[4:7], s78 offen offset:2048 sc1
    s_add_u32 s78, s78, 4096
    buffer_store_dwordx4 v[72:75], v76, s[4:7], s78 offen offset:0 sc1
    s_mov_b32 s91, 0
    s_branch L_p0_x_234008
L_p0_mod2_234013:
    s_waitcnt vmcnt(10)
    v_lshlrev_b32 v58, 16, v58
    v_lshlrev_b32 v59, 16, v59
    v_lshlrev_b32 v60, 16, v60
    v_lshlrev_b32 v61, 16, v61
    v_lshlrev_b32 v62, 16, v62
    v_mul_f32 v28, 0xbfb8aa3b, v58
    v_mul_f32 v29, 0xbfb8aa3b, v59
    v_mul_f32 v30, 0xbfb8aa3b, v60
    v_mul_f32 v31, 0xbfb8aa3b, v61
    v_mul_f32 v32, 0xbfb8aa3b, v62
    v_exp_f32 v28, v28
    v_exp_f32 v29, v29
    v_exp_f32 v30, v30
    v_exp_f32 v31, v31
    v_exp_f32 v32, v32
    v_add_f32 v28, 1.0, v28
    v_add_f32 v29, 1.0, v29
    v_add_f32 v30, 1.0, v30
    v_add_f32 v31, 1.0, v31
    v_add_f32 v32, 1.0, v32
    v_rcp_f32 v28, v28
    v_rcp_f32 v29, v29
    v_rcp_f32 v30, v30
    v_rcp_f32 v31, v31
    v_rcp_f32 v32, v32
    v_mul_f32 v58, v58, v28
    v_mul_f32 v59, v59, v29
    v_mul_f32 v60, v60, v30
    v_mul_f32 v61, v61, v31
    v_mul_f32 v62, v62, v32
    v_cvt_pk_bf16_f32 v58, v58, v58
    v_cvt_pk_bf16_f32 v59, v59, v59
    v_cvt_pk_bf16_f32 v60, v60, v60
    v_cvt_pk_bf16_f32 v61, v61, v61
    v_cvt_pk_bf16_f32 v62, v62, v62
    v_and_b32 v65, 0xffff, v58
    v_and_b32 v58, 0xffff0000, v58
    v_and_b32 v66, 0xffff, v59
    v_and_b32 v59, 0xffff0000, v59
    v_and_b32 v67, 0xffff, v60
    v_and_b32 v60, 0xffff0000, v60
    v_and_b32 v68, 0xffff, v61
    v_and_b32 v61, 0xffff0000, v61
    v_and_b32 v69, 0xffff, v62
    v_and_b32 v62, 0xffff0000, v62
    s_waitcnt vmcnt(9)
    v_dot2_f32_bf16 v28, v38, v65, 0
    v_dot2_f32_bf16 v29, v38, v58, 0
    v_dot2_f32_bf16 v30, v39, v65, 0
    v_dot2_f32_bf16 v31, v39, v58, 0
    v_dot2_f32_bf16 v32, v40, v65, 0
    v_dot2_f32_bf16 v33, v40, v58, 0
    v_dot2_f32_bf16 v34, v41, v65, 0
    v_dot2_f32_bf16 v35, v41, v58, 0
    s_waitcnt vmcnt(8)
    v_dot2_f32_bf16 v28, v42, v66, v28
    v_dot2_f32_bf16 v29, v42, v59, v29
    v_dot2_f32_bf16 v30, v43, v66, v30
    v_dot2_f32_bf16 v31, v43, v59, v31
    v_dot2_f32_bf16 v32, v44, v66, v32
    v_dot2_f32_bf16 v33, v44, v59, v33
    v_dot2_f32_bf16 v34, v45, v66, v34
    v_dot2_f32_bf16 v35, v45, v59, v35
    s_waitcnt vmcnt(7)
    v_dot2_f32_bf16 v28, v46, v67, v28
    v_dot2_f32_bf16 v29, v46, v60, v29
    v_dot2_f32_bf16 v30, v47, v67, v30
    v_dot2_f32_bf16 v31, v47, v60, v31
    v_dot2_f32_bf16 v32, v48, v67, v32
    v_dot2_f32_bf16 v33, v48, v60, v33
    v_dot2_f32_bf16 v34, v49, v67, v34
    v_dot2_f32_bf16 v35, v49, v60, v35
    s_waitcnt vmcnt(6)
    v_dot2_f32_bf16 v28, v50, v68, v28
    v_dot2_f32_bf16 v29, v50, v61, v29
    v_dot2_f32_bf16 v30, v51, v68, v30
    v_dot2_f32_bf16 v31, v51, v61, v31
    v_dot2_f32_bf16 v32, v52, v68, v32
    v_dot2_f32_bf16 v33, v52, v61, v33
    v_dot2_f32_bf16 v34, v53, v68, v34
    v_dot2_f32_bf16 v35, v53, v61, v35
    s_waitcnt vmcnt(5)
    v_dot2_f32_bf16 v28, v54, v69, v28
    v_dot2_f32_bf16 v29, v54, v62, v29
    v_dot2_f32_bf16 v30, v55, v69, v30
    v_dot2_f32_bf16 v31, v55, v62, v31
    v_dot2_f32_bf16 v32, v56, v69, v32
    v_dot2_f32_bf16 v33, v56, v62, v33
    v_dot2_f32_bf16 v34, v57, v69, v34
    v_dot2_f32_bf16 v35, v57, v62, v35
    s_nop 0
    v_add_f32_dpp v28, v28, v28 row_ror:8 row_mask:0xf bank_mask:0xf
    v_add_f32_dpp v29, v29, v29 row_ror:8 row_mask:0xf bank_mask:0xf
    v_add_f32_dpp v30, v30, v30 row_ror:8 row_mask:0xf bank_mask:0xf
    v_add_f32_dpp v31, v31, v31 row_ror:8 row_mask:0xf bank_mask:0xf
    v_add_f32_dpp v32, v32, v32 row_ror:8 row_mask:0xf bank_mask:0xf
    v_add_f32_dpp v33, v33, v33 row_ror:8 row_mask:0xf bank_mask:0xf
    v_add_f32_dpp v34, v34, v34 row_ror:8 row_mask:0xf bank_mask:0xf
    v_add_f32_dpp v35, v35, v35 row_ror:8 row_mask:0xf bank_mask:0xf
    v_lshrrev_b32 v36, 4, v1
    v_lshlrev_b32 v36, 8, v36
    v_and_b32 v63, 7, v1
    v_lshl_add_u32 v36, v63, 5, v36
    s_lshl_b32 s78, s10, 10
    s_add_u32 s78, s78, 159744
    v_add_u32 v36, s78, v36
    s_mov_b32 exec_lo, 0x00ff00ff
    s_mov_b32 exec_hi, 0x00ff00ff
    ds_write_b128 v36, v[28:31]
    ds_write_b128 v36, v[32:35] offset:16
    s_mov_b64 exec, -1
    s_mov_b64 exec, 1
    v_mov_b32 v24, 158728
    v_mov_b32 v25, 1
    s_waitcnt lgkmcnt(0)
    ds_add_u32 v24, v25
    s_mov_b64 exec, -1
    s_mov_b32 s91, 3
    s_cmp_lg_u32 s10, 0
    s_cbranch_scc1 L_p0_xgo_234020
L_p0_fin4_234011:
    v_mov_b32 v24, 158728
    s_mov_b32 s78, 8388608
L_spin_234023:
    ds_read_b32 v25, v24
    s_sub_u32 s78, s78, 1
    s_cbranch_scc1 L_spin_out_234024
    s_waitcnt lgkmcnt(0)
    v_cmp_gt_u32 vcc, 4, v25
    s_sleep 1
    s_cbranch_vccnz L_spin_234023
L_spin_out_234024:
    s_waitcnt lgkmcnt(0)
    v_lshlrev_b32 v36, 2, v1
    v_add_u32 v64, 159744, v36
    ds_read_b32 v38, v64 offset:0
    ds_read_b32 v39, v64 offset:256
    ds_read_b32 v40, v64 offset:512
    ds_read_b32 v41, v64 offset:768
    ds_read_b32 v42, v64 offset:1024
    ds_read_b32 v43, v64 offset:1280
    ds_read_b32 v44, v64 offset:1536
    ds_read_b32 v45, v64 offset:1792
    ds_read_b32 v46, v64 offset:2048
    ds_read_b32 v47, v64 offset:2304
    ds_read_b32 v48, v64 offset:2560
    ds_read_b32 v49, v64 offset:2816
    ds_read_b32 v50, v64 offset:3072
    ds_read_b32 v51, v64 offset:3328
    ds_read_b32 v52, v64 offset:3584
    ds_read_b32 v53, v64 offset:3840
    s_and_b32 s78, s2, 3
    s_lshr_b32 s79, s2, 2
    s_mul_i32 s87, s79, 26
    s_lshr_b32 s87, s87, 8
    s_bitcmp1_b32 0x12, s87
    s_cselect_b32 s87, 1.0, 0
    s_cmp_eq_u32 s78, 0
    s_cselect_b32 s87, s87, 0
    s_mul_i32 s88, s78, 15360
    s_lshl_b32 s89, s79, 8
    s_add_u32 s88, s88, s89
    s_add_u32 s88, s88, 36864
    s_waitcnt lgkmcnt(0)
    v_add_f32 v38, v38, v46
    v_add_f32 v39, v39, v47
    v_add_f32 v40, v40, v48
    v_add_f32 v41, v41, v49
    v_add_f32 v42, v42, v50
    v_add_f32 v43, v43, v51
    v_add_f32 v44, v44, v52
    v_add_f32 v45, v45, v53
    v_add_f32 v38, v38, v42
    v_add_f32 v39, v39, v43
    v_add_f32 v40, v40, v44
    v_add_f32 v41, v41, v45
    v_add_f32 v38, v38, v40
    v_add_f32 v39, v39, v41
    v_add_f32 v38, v38, v39
    v_add_f32 v38, s87, v38
    buffer_store_dword v38, v36, s[4:7], s88 offen sc1
    s_sub_u32 s87, s79, 30
    s_cmp_ge_u32 s87, 20
    s_cbranch_scc1 L_qkv_nob_234025
    s_cmp_ge_u32 s87, 10
    s_cselect_b32 s88, 10, 0
    s_cselect_b32 s89, 0, 128
    s_sub_u32 s87, s87, s88
    s_lshl_b32 s87, s87, 11
    s_add_u32 s87, s87, s89
    s_lshl_b32 s78, s78, 5
    s_add_u32 s87, s87, s78
    s_add_u32 s87, s87, 16384
    v_cvt_pk_bf16_f32 v39, v38, v38
    v_lshrrev_b32 v36, 3, v1
    v_and_b32 v64, 7, v1
    v_and_b32 v40, 0xffff0000, v39
    v_lshlrev_b32 v36, 8, v36
    v_sub_f32 v40, v38, v40
    v_lshl_add_u32 v36, v64, 1, v36
    v_cvt_pk_bf16_f32 v40, v40, v40
    buffer_store_short v39, v36, s[4:7], s87 offen sc1
    buffer_store_short v40, v36, s[4:7], s87 offen offset:16 sc1
L_qkv_nob_234025:
    s_lshl_b32 s82, s2, 2
    s_add_u32 s82, s82, 806912
    s_mov_b32 s81, 0xff
    s_branch L_p0_flag3_234019
L_p0_w4_234010:
    s_cmp_lt_u32 s2, 240
    s_cselect_b32 s91, 6, 3
    s_branch L_p0_x_234008
L_p0_pack_234006:
    s_lshr_b32 s87, s2, 1
    s_lshl_b32 s87, s87, 1
    s_add_u32 s87, s87, s10
    s_sub_u32 s87, s87, 5
    s_cmp_ge_u32 s87, 240
    s_cbranch_scc1 L_p0_x_234008
    s_setprio 3
    s_mul_i32 s78, s87, 1093
    s_lshr_b32 s78, s78, 16
    s_mul_i32 s79, s78, 60
    s_sub_u32 s87, s87, s79
    s_and_b32 s88, s2, 1
    s_lshl_b32 s88, s88, 2
    s_add_u32 s88, s88, s78
    s_lshl_b32 s82, s78, 6
    s_add_u32 s82, s82, s87
    s_lshl_b32 s82, s82, 2
    s_add_u32 s82, s82, 807936
    s_mul_i32 s89, s87, 3277
    s_lshr_b32 s89, s89, 16
    s_mul_i32 s79, s89, 20
    s_sub_u32 s87, s87, s79
    s_mul_i32 s81, s87, 122880
    s_mul_i32 s79, s89, 1280
    s_add_u32 s81, s81, s79
    s_mul_i32 s79, s88, 160
    s_add_u32 s81, s81, s79
    s_mul_i32 s90, s88, 15
    s_mul_i32 s79, s89, 5
    s_add_u32 s90, s90, s79
    s_mul_i32 s90, s90, 20
    s_add_u32 s90, s90, s87
    s_lshl_b32 s90, s90, 10
    s_add_u32 s90, s90, 21692416
    s_sub_u32 s88, s10, 5
    s_mul_i32 s88, s88, 8192
    s_add_u32 s88, s88, 92928
    s_mov_b32 s74, 2457600
    s_mov_b32 s75, 0x20000
    v_and_b32 v29, 15, v1
    v_lshrrev_b32 v28, 4, v1
    v_mul_u32_u24 v28, 3840, v28
    v_lshl_add_u32 v28, v29, 4, v28
    v_cmp_lt_u32 vcc, 9, v29
    v_mov_b32 v29, 0x40000000
    s_nop 0
    v_cndmask_b32 v28, v28, v29, vcc
    s_mov_b32 s79, 0
    s_add_u32 s78, s88, 0
    s_mov_b32 m0, s78
    s_add_u32 s79, s79, s81
    buffer_load_dwordx4 v28, s[72:75], s79 offen lds
    s_mov_b32 s79, 30720
    s_add_u32 s78, s88, 1024
    s_mov_b32 m0, s78
    s_add_u32 s79, s79, s81
    buffer_load_dwordx4 v28, s[72:75], s79 offen lds
    s_mov_b32 s79, 61440
    s_add_u32 s78, s88, 2048
    s_mov_b32 m0, s78
    s_add_u32 s79, s79, s81
    buffer_load_dwordx4 v28, s[72:75], s79 offen lds
    s_mov_b32 s79, 92160
    s_add_u32 s78, s88, 3072
    s_mov_b32 m0, s78
    s_add_u32 s79, s79, s81
    buffer_load_dwordx4 v28, s[72:75], s79 offen lds
    s_mov_b32 s79, 15360
    s_add_u32 s78, s88, 4096
    s_mov_b32 m0, s78
    s_add_u32 s79, s79, s81
    buffer_load_dwordx4 v28, s[72:75], s79 offen lds
    s_mov_b32 s79, 46080
    s_add_u32 s78, s88, 5120
    s_mov_b32 m0, s78
    s_add_u32 s79, s79, s81
    buffer_load_dwordx4 v28, s[72:75], s79 offen lds
    s_mov_b32 s79, 76800
    s_add_u32 s78, s88, 6144
    s_mov_b32 m0, s78
    s_add_u32 s79, s79, s81
    buffer_load_dwordx4 v28, s[72:75], s79 offen lds
    s_mov_b32 s79, 107520
    s_add_u32 s78, s88, 7168
    s_mov_b32 m0, s78
    s_add_u32 s79, s79, s81
    buffer_load_dwordx4 v28, s[72:75], s79 offen lds
    s_mov_b32 s91, 1
    s_and_b32 s81, s2, 1
    s_lshl_b32 s81, 0x55, s81
    s_branch L_p0_x_234008
L_p0_pack2_234014:
    s_cmp_eq_u32 s89, 2
    s_cbranch_scc1 L_p0_pv_234026
    v_lshrrev_b32 v31, 2, v1
    v_lshlrev_b32 v30, 8, v31
    v_add_u32 v30, s88, v30
    v_and_b32 v31, 3, v1
    v_lshlrev_b32 v32, 4, v1
    v_mul_u32_u24 v57, 40, v31
    v_add_u32 v57, v57, v30
    v_lshrrev_b32 v56, 1, v31
    v_mul_u32_u24 v56, 40, v56
    v_and_b32 v31, 1, v31
    v_lshl_add_u32 v56, v31, 4, v56
    v_add_u32 v56, v56, v30
    s_waitcnt vmcnt(0)
    ds_read_b64_tr_b16 v[36:37], v56 offset:0
    ds_read_b64_tr_b16 v[38:39], v56 offset:4096
    ds_read_b64_tr_b16 v[40:41], v56 offset:8
    ds_read_b64_tr_b16 v[42:43], v56 offset:4104
    ds_read_b64_tr_b16 v[44:45], v56 offset:80
    ds_read_b64_tr_b16 v[46:47], v56 offset:4176
    ds_read_b64_tr_b16 v[48:49], v56 offset:88
    ds_read_b64_tr_b16 v[50:51], v56 offset:4184
    ds_read_b64_tr_b16 v[52:53], v57 offset:32
    ds_read_b64_tr_b16 v[54:55], v57 offset:4128
    s_waitcnt lgkmcnt(8)
    buffer_store_dwordx4 v[36:39], v32, s[4:7], s90 offen sc1
    s_add_u32 s90, s90, 20480
    s_waitcnt lgkmcnt(6)
    buffer_store_dwordx4 v[40:43], v32, s[4:7], s90 offen sc1
    s_add_u32 s90, s90, 20480
    s_waitcnt lgkmcnt(4)
    buffer_store_dwordx4 v[44:47], v32, s[4:7], s90 offen sc1
    s_add_u32 s90, s90, 20480
    s_waitcnt lgkmcnt(2)
    buffer_store_dwordx4 v[48:51], v32, s[4:7], s90 offen sc1
    s_add_u32 s90, s90, 20480
    s_waitcnt lgkmcnt(0)
    buffer_store_dwordx4 v[52:55], v32, s[4:7], s90 offen sc1
    s_branch L_p0_pst_234027
L_p0_pv_234026:
    v_lshrrev_b32 v31, 2, v1
    v_lshlrev_b32 v30, 8, v31
    v_add_u32 v30, s88, v30
    v_and_b32 v31, 3, v1
    v_lshlrev_b32 v32, 4, v1
    v_lshl_add_u32 v56, v31, 3, v30
    s_waitcnt vmcnt(0)
    ds_read_b64_tr_b16 v[36:37], v56 offset:0
    ds_read_b64_tr_b16 v[38:39], v56 offset:4096
    ds_read_b64_tr_b16 v[40:41], v56 offset:32
    ds_read_b64_tr_b16 v[42:43], v56 offset:4128
    ds_read_b64_tr_b16 v[44:45], v56 offset:64
    ds_read_b64_tr_b16 v[46:47], v56 offset:4160
    ds_read_b64_tr_b16 v[48:49], v56 offset:96
    ds_read_b64_tr_b16 v[50:51], v56 offset:4192
    ds_read_b64_tr_b16 v[52:53], v56 offset:128
    ds_read_b64_tr_b16 v[54:55], v56 offset:4224
    s_waitcnt lgkmcnt(8)
    buffer_store_dwordx4 v[36:39], v32, s[4:7], s90 offen sc1
    s_add_u32 s90, s90, 20480
    s_waitcnt lgkmcnt(6)
    buffer_store_dwordx4 v[40:43], v32, s[4:7], s90 offen sc1
    s_add_u32 s90, s90, 20480
    s_waitcnt lgkmcnt(4)
    buffer_store_dwordx4 v[44:47], v32, s[4:7], s90 offen sc1
    s_add_u32 s90, s90, 20480
    s_waitcnt lgkmcnt(2)
    buffer_store_dwordx4 v[48:51], v32, s[4:7], s90 offen sc1
    s_add_u32 s90, s90, 20480
    s_waitcnt lgkmcnt(0)
    buffer_store_dwordx4 v[52:55], v32, s[4:7], s90 offen sc1
L_p0_pst_234027:
L_p0_flag3_234019:
    s_add_u32 s78, s21, 1
    v_mov_b32 v25, s78
    v_lshlrev_b32 v24, 11, v1
    s_waitcnt vmcnt(0)
    s_mov_b32 exec_lo, s81
    s_mov_b32 exec_hi, 0
    buffer_store_dword v25, v24, s[4:7], s82 offen sc1
    s_mov_b64 exec, -1
    s_setprio 0
    s_mov_b32 s91, 3
    s_branch L_p0_xgo_234020
L_p0_const_234007:
    s_mov_b32 s91, 2
    v_lshlrev_b32 v24, 7, v1
    s_and_b32 s78, s2, 7
    s_lshl_b32 s78, s78, 11
    s_add_u32 s78, s78, 806912
    s_mov_b64 exec, 0xffff
    buffer_load_dword v25, v24, s[4:7], s78 offen sc1
    s_mov_b64 exec, -1
    s_branch L_p0_x_234008
L_p0_const2_234015:
    v_bfe_u32 v36, v1, 3, 1
    v_subrev_u32 v36, 1, v36
    v_and_b32 v32, 0x3f803f80, v36
    v_and_b32 v33, 0x3f803f80, v36
    v_and_b32 v34, 0x3f803f80, v36
    v_and_b32 v35, 0x3f803f80, v36
    v_lshrrev_b32 v36, 4, v1
    v_mul_u32_u24 v36, 10240, v36
    v_add_u32 v36, v36, v20
    s_lshl_b32 s78, s77, 6
    s_lshl_b32 s79, s76, 1
    s_add_u32 s78, s78, s79
    s_mul_i32 s78, s78, 10496
    s_add_u32 s78, s78, 4007936
    s_mov_b32 exec_hi, 0
    buffer_store_dwordx4 v[32:35], v36, s[4:7], s78 offen sc1
    s_mov_b64 exec, -1
    s_getpc_b64 s[68:69]
L_pc:
    s_sub_u32 s68, s68, L_pc-adaLN_cond__mha_block__glu_gated_glu__prompt_kernel
    s_subb_u32 s69, s69, 0
    s_lshr_b32 s78, s2, 3
    s_mul_i32 s78, s78, 2048
    v_lshlrev_b32 v37, 4, v1
    v_add_u32 v37, s78, v37
    v_min_u32 v37, 36944, v37
    global_load_dwordx4 v[40:43], v37, s[68:69] offset:0
    global_load_dwordx4 v[40:43], v37, s[68:69] offset:1024
    s_waitcnt vmcnt(3)
    s_branch L_p0_stats_234018
L_p0_x_234008:
    s_barrier
    s_cmp_eq_u32 s91, 0
    s_cbranch_scc1 L_p0_mod2_234013
    s_cmp_eq_u32 s91, 1
    s_cbranch_scc1 L_p0_pack2_234014
L_p0_xgo_234020:
    buffer_load_dwordx4 v[104:107], v230, s[12:15], s83 offen
    s_add_u32 s83, s83, 10240
    buffer_load_dwordx4 v[108:111], v230, s[12:15], s83 offen
    s_add_u32 s83, s83, 10240
    buffer_load_dwordx4 v[112:115], v230, s[12:15], s83 offen
    s_add_u32 s83, s83, 10240
    buffer_load_dwordx4 v[116:119], v230, s[12:15], s83 offen
    s_add_u32 s83, s83, 10240
    buffer_load_dwordx4 v[120:123], v230, s[12:15], s83 offen
    s_add_u32 s83, s83, 10240
    buffer_load_dwordx4 v[124:127], v230, s[12:15], s83 offen
    s_add_u32 s83, s83, 10240
    buffer_load_dwordx4 v[128:131], v230, s[12:15], s83 offen
    s_add_u32 s83, s83, 10240
    buffer_load_dwordx4 v[132:135], v230, s[12:15], s83 offen
    s_add_u32 s83, s83, 10240
    s_mov_b32 s83, s84
    buffer_load_dwordx4 v[136:139], v230, s[12:15], s83 offen
    s_add_u32 s83, s83, 10240
    buffer_load_dwordx4 v[140:143], v230, s[12:15], s83 offen
    v_and_b32 v144, 3, v16
    v_lshrrev_b32 v145, 2, v16
    v_mul_u32_u24 v17, 12, v145
    v_add_u32 v17, v17, v144
    v_xor_b32 v17, v17, v15
    v_lshlrev_b32 v17, 4, v17
    v_lshl_add_u32 v17, v144, 8, v17
    v_lshl_add_u32 v17, v145, 12, v17
    s_lshl_b32 s78, s10, 13
    v_add_u32 v19, s78, v17
    s_lshl_b32 s78, s85, 13
    s_lshl_b32 s79, s86, 9
    s_add_u32 s78, s78, s79
    v_add_u32 v17, s78, v17
    v_lshlrev_b32 v144, 5, v16
    s_lshl_b32 s78, s10, 8
    s_add_u32 s78, s78, 81920
    v_add_u32 v231, s78, v144
    s_lshl_b32 s78, s85, 8
    s_add_u32 s78, s78, 81920
    v_add_u32 v232, s78, v144
    v_lshlrev_b32 v233, 3, v15
    v_add_u32 v233, 87040, v233
    s_lshl_b32 s78, s86, 6
    v_add_u32 v234, s78, v233
    v_xor_b32 v18, 128, v19
    v_mul_u32_u24 v144, 80, v15
    s_lshl_b32 s78, s10, 3
    s_add_u32 s78, s78, 87552
    v_add_u32 v235, s78, v144
    s_mul_i32 s78, s86, 640
    s_lshl_b32 s79, s85, 3
    s_add_u32 s78, s78, s79
    s_add_u32 s78, s78, 87552
    v_add_u32 v236, s78, v144
    s_load_dwordx8 s[56:63], s[0:1], 16
    s_load_dwordx2 s[64:65], s[0:1], 48
    s_sub_u32 s40, s10, 4
    s_mul_i32 s43, s40, 25600
    s_lshl_b32 s47, s40, 8
    s_add_u32 s47, s47, s2
    v_lshlrev_b32 v6, 4, v1
    s_mul_i32 s45, s47, 7168
    s_add_u32 s45, s45, 27181056
    s_mul_i32 s41, s47, 3277
    s_lshr_b32 s41, s41, 16
    s_mul_i32 s42, s41, 20
    s_sub_u32 s42, s47, s42
    s_lshl_b32 s46, s41, 8
    s_add_u32 s46, s46, 798720
    s_mov_b32 s66, s47
    s_mul_i32 s41, s41, 112
    s_min_u32 s41, s41, 3344
    s_mul_i32 s42, s42, 110592
    s_add_u32 s44, s41, s42
    s_cmp_ge_u32 s66, 620
    s_cselect_b32 s44, 1073741824, s44
    v_lshrrev_b32 v7, 5, v1
    v_bfe_u32 v14, v1, 3, 2
    v_lshl_add_u32 v7, v7, 3, v14
    v_mul_u32_u24 v7, 3456, v7
    v_and_b32 v14, 7, v1
    v_lshl_add_u32 v7, v14, 4, v7
    v_cmp_eq_u32 vcc, 7, v14
    v_mov_b32 v14, 1073741824
    s_nop 0
    v_cndmask_b32 v7, v7, v14, vcc
    v_and_b32 v14, 15, v1
    v_lshrrev_b32 v8, 4, v1
    v_mul_u32_u24 v8, 1280, v8
    v_lshl_add_u32 v8, v14, 4, v8
    v_cmp_lt_u32 vcc, 9, v14
    v_mov_b32 v14, 0x40000000
    s_nop 0
    v_cndmask_b32 v8, v8, v14, vcc
    s_sub_u32 s66, s47, 432
    s_max_i32 s66, s66, 0
    s_waitcnt lgkmcnt(0)
    s_mov_b32 s28, s60
    s_mov_b32 s29, s61
    s_mov_b32 s32, s62
    s_mov_b32 s33, s63
    s_mov_b32 s30, 2211840
    s_mov_b32 s31, 0x20000
    s_mov_b32 s34, 2211840
    s_mov_b32 s35, 0x20000
    s_cmp_ge_u32 s66, 160
    s_cbranch_scc1 L_hlp_isd_234028
    s_mul_i32 s49, s66, 5120
    s_add_u32 s49, s49, 24150016
    s_mul_i32 s41, s66, 3277
    s_lshr_b32 s41, s41, 16
    s_mul_i32 s42, s41, 20
    s_sub_u32 s66, s66, s42
    s_mul_i32 s48, s41, 160
    s_lshl_b32 s50, s41, 8
    s_add_u32 s50, s50, 786432
    s_mul_i32 s41, s66, 51200
    s_sub_u32 s42, s66, 16
    s_mul_i32 s42, s42, 204800
    s_add_u32 s42, s42, 20480
    s_cmp_ge_u32 s66, 16
    s_cselect_b32 s41, s42, s41
    s_cselect_b32 s51, 80, 20
    s_cselect_b32 s52, 40, 4
    s_cselect_b32 s53, 20, 8
    s_add_u32 s48, s48, s41
    s_mov_b32 s36, s56
    s_mov_b32 s37, s57
    s_mov_b32 s38, 819200
    s_branch L_hlp_go_234029
L_hlp_isd_234028:
    s_sub_u32 s66, s66, 160
    s_mul_i32 s49, s66, 5120
    s_add_u32 s49, s49, 24969216
    s_mul_i32 s41, s66, 1214
    s_lshr_b32 s41, s41, 16
    s_mul_i32 s42, s41, 54
    s_sub_u32 s66, s66, s42
    s_mul_i32 s48, s41, 160
    s_lshl_b32 s50, s41, 8
    s_add_u32 s50, s50, 788480
    s_mul_i32 s41, s66, 40960
    s_add_u32 s48, s48, s41
    s_mov_b32 s51, 16
    s_mov_b32 s52, 8
    s_mov_b32 s53, 4
    s_mov_b32 s36, s64
    s_mov_b32 s37, s65
    s_mov_b32 s38, 2211840
L_hlp_go_234029:
    s_mov_b32 s39, 0x20000
    s_mul_i32 s51, s51, 1280
    s_mul_i32 s52, s52, 1280
    s_mul_i32 s53, s53, 1280
    s_cmp_lt_u32 s47, 432
    s_cselect_b32 s48, 1073741824, s48
    s_cmp_eq_u32 s91, 2
    s_cbranch_scc1 L_p0_const2_234015
    s_cmp_eq_u32 s91, 0
    s_cbranch_scc1 L_p0_mod2_234013
    s_cmp_eq_u32 s91, 1
    s_cbranch_scc1 L_p0_pack2_234014
    s_cmp_eq_u32 s91, 6
    s_cbranch_scc1 L_p0_fin4_234011
L_p0_none2_234017:
    s_waitcnt vmcnt(0)
L_p0_stats_234018:
    s_mov_b32 s78, 0x3f803f80
    v_dot2_f32_bf16 v144, v104, s78, 0
    v_dot2_f32_bf16 v145, v104, v104, 0
    v_dot2_f32_bf16 v144, v105, s78, v144
    v_dot2_f32_bf16 v145, v105, v105, v145
    v_dot2_f32_bf16 v144, v106, s78, v144
    v_dot2_f32_bf16 v145, v106, v106, v145
    v_dot2_f32_bf16 v144, v107, s78, v144
    v_dot2_f32_bf16 v145, v107, v107, v145
    v_dot2_f32_bf16 v146, v108, s78, 0
    v_dot2_f32_bf16 v147, v108, v108, 0
    v_dot2_f32_bf16 v146, v109, s78, v146
    v_dot2_f32_bf16 v147, v109, v109, v147
    v_dot2_f32_bf16 v146, v110, s78, v146
    v_dot2_f32_bf16 v147, v110, v110, v147
    v_dot2_f32_bf16 v146, v111, s78, v146
    v_dot2_f32_bf16 v147, v111, v111, v147
    v_dot2_f32_bf16 v148, v112, s78, 0
    v_dot2_f32_bf16 v149, v112, v112, 0
    v_dot2_f32_bf16 v148, v113, s78, v148
    v_dot2_f32_bf16 v149, v113, v113, v149
    v_dot2_f32_bf16 v148, v114, s78, v148
    v_dot2_f32_bf16 v149, v114, v114, v149
    v_dot2_f32_bf16 v148, v115, s78, v148
    v_dot2_f32_bf16 v149, v115, v115, v149
    v_dot2_f32_bf16 v150, v116, s78, 0
    v_dot2_f32_bf16 v151, v116, v116, 0
    v_dot2_f32_bf16 v150, v117, s78, v150
    v_dot2_f32_bf16 v151, v117, v117, v151
    v_dot2_f32_bf16 v150, v118, s78, v150
    v_dot2_f32_bf16 v151, v118, v118, v151
    v_dot2_f32_bf16 v150, v119, s78, v150
    v_dot2_f32_bf16 v151, v119, v119, v151
    v_dot2_f32_bf16 v152, v120, s78, 0
    v_dot2_f32_bf16 v153, v120, v120, 0
    v_dot2_f32_bf16 v152, v121, s78, v152
    v_dot2_f32_bf16 v153, v121, v121, v153
    v_dot2_f32_bf16 v152, v122, s78, v152
    v_dot2_f32_bf16 v153, v122, v122, v153
    v_dot2_f32_bf16 v152, v123, s78, v152
    v_dot2_f32_bf16 v153, v123, v123, v153
    v_dot2_f32_bf16 v154, v124, s78, 0
    v_dot2_f32_bf16 v155, v124, v124, 0
    v_dot2_f32_bf16 v154, v125, s78, v154
    v_dot2_f32_bf16 v155, v125, v125, v155
    v_dot2_f32_bf16 v154, v126, s78, v154
    v_dot2_f32_bf16 v155, v126, v126, v155
    v_dot2_f32_bf16 v154, v127, s78, v154
    v_dot2_f32_bf16 v155, v127, v127, v155
    v_dot2_f32_bf16 v156, v128, s78, 0
    v_dot2_f32_bf16 v157, v128, v128, 0
    v_dot2_f32_bf16 v156, v129, s78, v156
    v_dot2_f32_bf16 v157, v129, v129, v157
    v_dot2_f32_bf16 v156, v130, s78, v156
    v_dot2_f32_bf16 v157, v130, v130, v157
    v_dot2_f32_bf16 v156, v131, s78, v156
    v_dot2_f32_bf16 v157, v131, v131, v157
    v_dot2_f32_bf16 v158, v132, s78, 0
    v_dot2_f32_bf16 v159, v132, v132, 0
    v_dot2_f32_bf16 v158, v133, s78, v158
    v_dot2_f32_bf16 v159, v133, v133, v159
    v_dot2_f32_bf16 v158, v134, s78, v158
    v_dot2_f32_bf16 v159, v134, v134, v159
    v_dot2_f32_bf16 v158, v135, s78, v158
    v_dot2_f32_bf16 v159, v135, v135, v159
    v_dot2_f32_bf16 v160, v136, s78, 0
    v_dot2_f32_bf16 v161, v136, v136, 0
    v_dot2_f32_bf16 v160, v137, s78, v160
    v_dot2_f32_bf16 v161, v137, v137, v161
    v_dot2_f32_bf16 v160, v138, s78, v160
    v_dot2_f32_bf16 v161, v138, v138, v161
    v_dot2_f32_bf16 v160, v139, s78, v160
    v_dot2_f32_bf16 v161, v139, v139, v161
    v_dot2_f32_bf16 v162, v140, s78, 0
    v_dot2_f32_bf16 v163, v140, v140, 0
    v_dot2_f32_bf16 v162, v141, s78, v162
    v_dot2_f32_bf16 v163, v141, v141, v163
    v_dot2_f32_bf16 v162, v142, s78, v162
    v_dot2_f32_bf16 v163, v142, v142, v163
    v_dot2_f32_bf16 v162, v143, s78, v162
    v_dot2_f32_bf16 v163, v143, v143, v163
    s_nop 0
    v_add_f32_dpp v144, v144, v144 quad_perm:[1,0,3,2] row_mask:0xf bank_mask:0xf
    v_add_f32_dpp v145, v145, v145 quad_perm:[1,0,3,2] row_mask:0xf bank_mask:0xf
    v_add_f32_dpp v146, v146, v146 quad_perm:[1,0,3,2] row_mask:0xf bank_mask:0xf
    v_add_f32_dpp v147, v147, v147 quad_perm:[1,0,3,2] row_mask:0xf bank_mask:0xf
    v_add_f32_dpp v148, v148, v148 quad_perm:[1,0,3,2] row_mask:0xf bank_mask:0xf
    v_add_f32_dpp v149, v149, v149 quad_perm:[1,0,3,2] row_mask:0xf bank_mask:0xf
    v_add_f32_dpp v150, v150, v150 quad_perm:[1,0,3,2] row_mask:0xf bank_mask:0xf
    v_add_f32_dpp v151, v151, v151 quad_perm:[1,0,3,2] row_mask:0xf bank_mask:0xf
    v_add_f32_dpp v152, v152, v152 quad_perm:[1,0,3,2] row_mask:0xf bank_mask:0xf
    v_add_f32_dpp v153, v153, v153 quad_perm:[1,0,3,2] row_mask:0xf bank_mask:0xf
    v_add_f32_dpp v154, v154, v154 quad_perm:[1,0,3,2] row_mask:0xf bank_mask:0xf
    v_add_f32_dpp v155, v155, v155 quad_perm:[1,0,3,2] row_mask:0xf bank_mask:0xf
    v_add_f32_dpp v156, v156, v156 quad_perm:[1,0,3,2] row_mask:0xf bank_mask:0xf
    v_add_f32_dpp v157, v157, v157 quad_perm:[1,0,3,2] row_mask:0xf bank_mask:0xf
    v_add_f32_dpp v158, v158, v158 quad_perm:[1,0,3,2] row_mask:0xf bank_mask:0xf
    v_add_f32_dpp v159, v159, v159 quad_perm:[1,0,3,2] row_mask:0xf bank_mask:0xf
    v_add_f32_dpp v160, v160, v160 quad_perm:[1,0,3,2] row_mask:0xf bank_mask:0xf
    v_add_f32_dpp v161, v161, v161 quad_perm:[1,0,3,2] row_mask:0xf bank_mask:0xf
    v_add_f32_dpp v162, v162, v162 quad_perm:[1,0,3,2] row_mask:0xf bank_mask:0xf
    v_add_f32_dpp v163, v163, v163 quad_perm:[1,0,3,2] row_mask:0xf bank_mask:0xf
    v_add_f32_dpp v144, v144, v144 quad_perm:[2,3,0,1] row_mask:0xf bank_mask:0xf
    v_add_f32_dpp v145, v145, v145 quad_perm:[2,3,0,1] row_mask:0xf bank_mask:0xf
    v_add_f32_dpp v146, v146, v146 quad_perm:[2,3,0,1] row_mask:0xf bank_mask:0xf
    v_add_f32_dpp v147, v147, v147 quad_perm:[2,3,0,1] row_mask:0xf bank_mask:0xf
    v_add_f32_dpp v148, v148, v148 quad_perm:[2,3,0,1] row_mask:0xf bank_mask:0xf
    v_add_f32_dpp v149, v149, v149 quad_perm:[2,3,0,1] row_mask:0xf bank_mask:0xf
    v_add_f32_dpp v150, v150, v150 quad_perm:[2,3,0,1] row_mask:0xf bank_mask:0xf
    v_add_f32_dpp v151, v151, v151 quad_perm:[2,3,0,1] row_mask:0xf bank_mask:0xf
    v_add_f32_dpp v152, v152, v152 quad_perm:[2,3,0,1] row_mask:0xf bank_mask:0xf
    v_add_f32_dpp v153, v153, v153 quad_perm:[2,3,0,1] row_mask:0xf bank_mask:0xf
    v_add_f32_dpp v154, v154, v154 quad_perm:[2,3,0,1] row_mask:0xf bank_mask:0xf
    v_add_f32_dpp v155, v155, v155 quad_perm:[2,3,0,1] row_mask:0xf bank_mask:0xf
    v_add_f32_dpp v156, v156, v156 quad_perm:[2,3,0,1] row_mask:0xf bank_mask:0xf
    v_add_f32_dpp v157, v157, v157 quad_perm:[2,3,0,1] row_mask:0xf bank_mask:0xf
    v_add_f32_dpp v158, v158, v158 quad_perm:[2,3,0,1] row_mask:0xf bank_mask:0xf
    v_add_f32_dpp v159, v159, v159 quad_perm:[2,3,0,1] row_mask:0xf bank_mask:0xf
    v_add_f32_dpp v160, v160, v160 quad_perm:[2,3,0,1] row_mask:0xf bank_mask:0xf
    v_add_f32_dpp v161, v161, v161 quad_perm:[2,3,0,1] row_mask:0xf bank_mask:0xf
    v_add_f32_dpp v162, v162, v162 quad_perm:[2,3,0,1] row_mask:0xf bank_mask:0xf
    v_add_f32_dpp v163, v163, v163 quad_perm:[2,3,0,1] row_mask:0xf bank_mask:0xf
    v_add_f32_dpp v144, v144, v144 row_half_mirror row_mask:0xf bank_mask:0xf
    v_add_f32_dpp v145, v145, v145 row_half_mirror row_mask:0xf bank_mask:0xf
    v_add_f32_dpp v146, v146, v146 row_half_mirror row_mask:0xf bank_mask:0xf
    v_add_f32_dpp v147, v147, v147 row_half_mirror row_mask:0xf bank_mask:0xf
    v_add_f32_dpp v148, v148, v148 row_half_mirror row_mask:0xf bank_mask:0xf
    v_add_f32_dpp v149, v149, v149 row_half_mirror row_mask:0xf bank_mask:0xf
    v_add_f32_dpp v150, v150, v150 row_half_mirror row_mask:0xf bank_mask:0xf
    v_add_f32_dpp v151, v151, v151 row_half_mirror row_mask:0xf bank_mask:0xf
    v_add_f32_dpp v152, v152, v152 row_half_mirror row_mask:0xf bank_mask:0xf
    v_add_f32_dpp v153, v153, v153 row_half_mirror row_mask:0xf bank_mask:0xf
    v_add_f32_dpp v154, v154, v154 row_half_mirror row_mask:0xf bank_mask:0xf
    v_add_f32_dpp v155, v155, v155 row_half_mirror row_mask:0xf bank_mask:0xf
    v_add_f32_dpp v156, v156, v156 row_half_mirror row_mask:0xf bank_mask:0xf
    v_add_f32_dpp v157, v157, v157 row_half_mirror row_mask:0xf bank_mask:0xf
    v_add_f32_dpp v158, v158, v158 row_half_mirror row_mask:0xf bank_mask:0xf
    v_add_f32_dpp v159, v159, v159 row_half_mirror row_mask:0xf bank_mask:0xf
    v_add_f32_dpp v160, v160, v160 row_half_mirror row_mask:0xf bank_mask:0xf
    v_add_f32_dpp v161, v161, v161 row_half_mirror row_mask:0xf bank_mask:0xf
    v_add_f32_dpp v162, v162, v162 row_half_mirror row_mask:0xf bank_mask:0xf
    v_add_f32_dpp v163, v163, v163 row_half_mirror row_mask:0xf bank_mask:0xf
    s_mov_b32 exec_lo, 0x01010101
    s_mov_b32 exec_hi, 0x01010101
    ds_write_b64 v235, v[144:145] offset:0
    ds_write_b64 v235, v[146:147] offset:640
    ds_write_b64 v235, v[148:149] offset:1280
    ds_write_b64 v235, v[150:151] offset:1920
    ds_write_b64 v235, v[152:153] offset:2560
    ds_write_b64 v235, v[154:155] offset:3200
    ds_write_b64 v235, v[156:157] offset:3840
    ds_write_b64 v235, v[158:159] offset:4480
    ds_write_b64 v236, v[160:161] offset:0
    ds_write_b64 v236, v[162:163] offset:640
    s_mov_b64 exec, -1
L_p0_b1_234012:
    s_waitcnt lgkmcnt(0)
    s_barrier
    s_cmp_lg_u32 s10, 4
    s_cbranch_scc1 L_p0_b2_234021
    v_mul_u32_u24 v36, 80, v1
    v_add_u32 v36, 87552, v36
    ds_read_b128 v[164:167], v36 offset:0
    ds_read_b128 v[168:171], v36 offset:16
    ds_read_b128 v[172:175], v36 offset:32
    ds_read_b128 v[176:179], v36 offset:48
    ds_read_b128 v[180:183], v36 offset:64
    v_lshlrev_b32 v36, 3, v1
    v_add_u32 v36, 87040, v36
    s_waitcnt lgkmcnt(0)
    v_add_f32 v164, v164, v166
    v_add_f32 v165, v165, v167
    v_add_f32 v164, v164, v168
    v_add_f32 v165, v165, v169
    v_add_f32 v164, v164, v170
    v_add_f32 v165, v165, v171
    v_add_f32 v164, v164, v172
    v_add_f32 v165, v165, v173
    v_add_f32 v164, v164, v174
    v_add_f32 v165, v165, v175
    v_add_f32 v164, v164, v176
    v_add_f32 v165, v165, v177
    v_add_f32 v164, v164, v178
    v_add_f32 v165, v165, v179
    v_add_f32 v164, v164, v180
    v_add_f32 v165, v165, v181
    v_add_f32 v164, v164, v182
    v_add_f32 v165, v165, v183
    v_mul_f32 v166, 0x3acccccd, v164
    v_mul_f32 v165, 0x3acccccd, v165
    v_fma_f32 v165, -v166, v166, v165
    v_max_f32 v165, 0, v165
    v_add_f32 v165, 0x3727c5ac, v165
    v_rsq_f32 v164, v165
    s_nop 0
    v_mul_f32_e64 v165, -v166, v164
    ds_write_b64 v36, v[164:165]
L_p0_b2_234021:
    s_waitcnt lgkmcnt(0)
    s_barrier
    s_add_u32 s21, s21, 1
    s_lshl_b32 s79, s10, 2
    s_lshr_b32 s81, 0xeca47520, s79
    s_and_b32 s81, s81, 15
    s_lshr_b32 s82, 0xedb98631, s79
    s_and_b32 s82, s82, 15
    s_mul_i32 s79, s77, 15
    s_add_u32 s81, s81, s79
    s_add_u32 s82, s82, s79
    s_mul_i32 s81, s81, 20480
    s_mul_i32 s82, s82, 20480
    s_add_u32 s81, s81, 21692416
    s_add_u32 s82, s82, 21692416
    s_cmp_eq_u32 s10, 7
    s_cselect_b32 s82, 0x40000000, s82
    s_cmp_eq_u32 s10, 7
    s_cbranch_scc1 L_p0_w7_234030
    v_mov_b32 v224, 158724
    s_mov_b32 s78, 8388608
L_spin_234032:
    ds_read_b32 v225, v224
    s_sub_u32 s78, s78, 1
    s_cbranch_scc1 L_spin_out_234033
    s_waitcnt lgkmcnt(0)
    v_cmp_gt_u32 vcc, 1, v225
    s_sleep 1
    s_cbranch_vccnz L_spin_234032
L_spin_out_234033:
    s_waitcnt lgkmcnt(0)
    s_branch L_p0_b3_234031
L_p0_w7_234030:
    v_lshlrev_b32 v235, 2, v1
    v_min_u32 v236, 15, v1
    v_lshlrev_b32 v236, 2, v236
    v_min_u32 v230, 59, v1
    v_lshlrev_b32 v230, 2, v230
    s_and_b32 s78, s2, 7
    s_lshl_b32 s78, s78, 11
    s_add_u32 s78, s78, 806912
    s_and_b32 s79, s77, 3
    s_lshl_b32 s79, s79, 8
    s_add_u32 s79, s79, 1024
    s_add_u32 s79, s79, s78
    s_mov_b32 s87, 1048576
L_p0_fp_234034:
    buffer_load_dword v224, v235, s[4:7], s78 offen sc1
    buffer_load_dword v225, v236, s[4:7], s78 offen offset:256 sc1
    buffer_load_dword v226, v230, s[4:7], s79 offen sc1
    s_sub_u32 s87, s87, 1
    s_cbranch_scc1 L_p0_fpo_234035
    s_waitcnt vmcnt(0)
    v_xor_b32 v224, s21, v224
    v_xor_b32 v225, s21, v225
    v_xor_b32 v226, s21, v226
    v_or3_b32 v224, v224, v225, v226
    v_cmp_ne_u32 vcc, 0, v224
    s_nop 0
    s_cbranch_vccnz L_p0_fp_234034
L_p0_fpo_234035:
    s_waitcnt vmcnt(0)
    v_mov_b32 v224, 158724
    v_mov_b32 v225, 1
    ds_write_b32 v224, v225
L_p0_b3_234031:
    s_cmp_ge_u32 s10, 5
    s_cselect_b32 s78, 0x40000000, 36864
    s_lshl_b32 s79, s10, 10
    s_add_u32 s78, s78, s79
    buffer_load_dwordx4 v[88:91], v20, s[4:7], s78 offen sc1
    s_add_u32 s78, s78, 15360
    buffer_load_dwordx4 v[92:95], v20, s[4:7], s78 offen sc1
    s_add_u32 s78, s78, 15360
    buffer_load_dwordx4 v[96:99], v20, s[4:7], s78 offen sc1
    s_add_u32 s78, s78, 15360
    buffer_load_dwordx4 v[100:103], v20, s[4:7], s78 offen sc1
    ds_read_b64 v[224:225], v233 offset:0
    ds_read_b64 v[226:227], v233 offset:64
    v_lshlrev_b32 v144, 16, v104
    v_and_b32 v145, 0xffff0000, v104
    v_lshlrev_b32 v146, 16, v105
    v_and_b32 v147, 0xffff0000, v105
    v_lshlrev_b32 v148, 16, v106
    v_and_b32 v149, 0xffff0000, v106
    v_lshlrev_b32 v150, 16, v107
    v_and_b32 v151, 0xffff0000, v107
    s_waitcnt lgkmcnt(1)
    v_pk_fma_f32 v[144:145], v[144:145], v[224:225], v[224:225] op_sel:[0,0,1] op_sel_hi:[1,0,1]
    v_pk_fma_f32 v[146:147], v[146:147], v[224:225], v[224:225] op_sel:[0,0,1] op_sel_hi:[1,0,1]
    v_pk_fma_f32 v[148:149], v[148:149], v[224:225], v[224:225] op_sel:[0,0,1] op_sel_hi:[1,0,1]
    v_pk_fma_f32 v[150:151], v[150:151], v[224:225], v[224:225] op_sel:[0,0,1] op_sel_hi:[1,0,1]
    ds_read_b64 v[228:229], v233 offset:128
    v_lshlrev_b32 v152, 16, v108
    v_and_b32 v153, 0xffff0000, v108
    v_lshlrev_b32 v154, 16, v109
    v_and_b32 v155, 0xffff0000, v109
    v_lshlrev_b32 v156, 16, v110
    v_and_b32 v157, 0xffff0000, v110
    v_lshlrev_b32 v158, 16, v111
    v_and_b32 v159, 0xffff0000, v111
    s_waitcnt lgkmcnt(1)
    v_pk_fma_f32 v[152:153], v[152:153], v[226:227], v[226:227] op_sel:[0,0,1] op_sel_hi:[1,0,1]
    v_pk_fma_f32 v[154:155], v[154:155], v[226:227], v[226:227] op_sel:[0,0,1] op_sel_hi:[1,0,1]
    v_pk_fma_f32 v[156:157], v[156:157], v[226:227], v[226:227] op_sel:[0,0,1] op_sel_hi:[1,0,1]
    v_pk_fma_f32 v[158:159], v[158:159], v[226:227], v[226:227] op_sel:[0,0,1] op_sel_hi:[1,0,1]
    ds_read_b64 v[224:225], v233 offset:192
    v_lshlrev_b32 v160, 16, v112
    v_and_b32 v161, 0xffff0000, v112
    v_lshlrev_b32 v162, 16, v113
    v_and_b32 v163, 0xffff0000, v113
    v_lshlrev_b32 v164, 16, v114
    v_and_b32 v165, 0xffff0000, v114
    v_lshlrev_b32 v166, 16, v115
    v_and_b32 v167, 0xffff0000, v115
    s_waitcnt lgkmcnt(1)
    v_pk_fma_f32 v[160:161], v[160:161], v[228:229], v[228:229] op_sel:[0,0,1] op_sel_hi:[1,0,1]
    v_pk_fma_f32 v[162:163], v[162:163], v[228:229], v[228:229] op_sel:[0,0,1] op_sel_hi:[1,0,1]
    v_pk_fma_f32 v[164:165], v[164:165], v[228:229], v[228:229] op_sel:[0,0,1] op_sel_hi:[1,0,1]
    v_pk_fma_f32 v[166:167], v[166:167], v[228:229], v[228:229] op_sel:[0,0,1] op_sel_hi:[1,0,1]
    ds_read_b64 v[226:227], v233 offset:256
    v_lshlrev_b32 v168, 16, v116
    v_and_b32 v169, 0xffff0000, v116
    v_lshlrev_b32 v170, 16, v117
    v_and_b32 v171, 0xffff0000, v117
    v_lshlrev_b32 v172, 16, v118
    v_and_b32 v173, 0xffff0000, v118
    v_lshlrev_b32 v174, 16, v119
    v_and_b32 v175, 0xffff0000, v119
    s_waitcnt lgkmcnt(1)
    v_pk_fma_f32 v[168:169], v[168:169], v[224:225], v[224:225] op_sel:[0,0,1] op_sel_hi:[1,0,1]
    v_pk_fma_f32 v[170:171], v[170:171], v[224:225], v[224:225] op_sel:[0,0,1] op_sel_hi:[1,0,1]
    v_pk_fma_f32 v[172:173], v[172:173], v[224:225], v[224:225] op_sel:[0,0,1] op_sel_hi:[1,0,1]
    v_pk_fma_f32 v[174:175], v[174:175], v[224:225], v[224:225] op_sel:[0,0,1] op_sel_hi:[1,0,1]
    ds_read_b64 v[228:229], v233 offset:320
    v_lshlrev_b32 v176, 16, v120
    v_and_b32 v177, 0xffff0000, v120
    v_lshlrev_b32 v178, 16, v121
    v_and_b32 v179, 0xffff0000, v121
    v_lshlrev_b32 v180, 16, v122
    v_and_b32 v181, 0xffff0000, v122
    v_lshlrev_b32 v182, 16, v123
    v_and_b32 v183, 0xffff0000, v123
    s_waitcnt lgkmcnt(1)
    v_pk_fma_f32 v[176:177], v[176:177], v[226:227], v[226:227] op_sel:[0,0,1] op_sel_hi:[1,0,1]
    v_pk_fma_f32 v[178:179], v[178:179], v[226:227], v[226:227] op_sel:[0,0,1] op_sel_hi:[1,0,1]
    v_pk_fma_f32 v[180:181], v[180:181], v[226:227], v[226:227] op_sel:[0,0,1] op_sel_hi:[1,0,1]
    v_pk_fma_f32 v[182:183], v[182:183], v[226:227], v[226:227] op_sel:[0,0,1] op_sel_hi:[1,0,1]
    ds_read_b64 v[224:225], v233 offset:384
    v_lshlrev_b32 v184, 16, v124
    v_and_b32 v185, 0xffff0000, v124
    v_lshlrev_b32 v186, 16, v125
    v_and_b32 v187, 0xffff0000, v125
    v_lshlrev_b32 v188, 16, v126
    v_and_b32 v189, 0xffff0000, v126
    v_lshlrev_b32 v190, 16, v127
    v_and_b32 v191, 0xffff0000, v127
    s_waitcnt lgkmcnt(1)
    v_pk_fma_f32 v[184:185], v[184:185], v[228:229], v[228:229] op_sel:[0,0,1] op_sel_hi:[1,0,1]
    v_pk_fma_f32 v[186:187], v[186:187], v[228:229], v[228:229] op_sel:[0,0,1] op_sel_hi:[1,0,1]
    v_pk_fma_f32 v[188:189], v[188:189], v[228:229], v[228:229] op_sel:[0,0,1] op_sel_hi:[1,0,1]
    v_pk_fma_f32 v[190:191], v[190:191], v[228:229], v[228:229] op_sel:[0,0,1] op_sel_hi:[1,0,1]
    ds_read_b64 v[226:227], v233 offset:448
    v_lshlrev_b32 v192, 16, v128
    v_and_b32 v193, 0xffff0000, v128
    v_lshlrev_b32 v194, 16, v129
    v_and_b32 v195, 0xffff0000, v129
    v_lshlrev_b32 v196, 16, v130
    v_and_b32 v197, 0xffff0000, v130
    v_lshlrev_b32 v198, 16, v131
    v_and_b32 v199, 0xffff0000, v131
    s_waitcnt lgkmcnt(1)
    v_pk_fma_f32 v[192:193], v[192:193], v[224:225], v[224:225] op_sel:[0,0,1] op_sel_hi:[1,0,1]
    v_pk_fma_f32 v[194:195], v[194:195], v[224:225], v[224:225] op_sel:[0,0,1] op_sel_hi:[1,0,1]
    v_pk_fma_f32 v[196:197], v[196:197], v[224:225], v[224:225] op_sel:[0,0,1] op_sel_hi:[1,0,1]
    v_pk_fma_f32 v[198:199], v[198:199], v[224:225], v[224:225] op_sel:[0,0,1] op_sel_hi:[1,0,1]
    ds_read_b64 v[228:229], v234 offset:0
    v_lshlrev_b32 v200, 16, v132
    v_and_b32 v201, 0xffff0000, v132
    v_lshlrev_b32 v202, 16, v133
    v_and_b32 v203, 0xffff0000, v133
    v_lshlrev_b32 v204, 16, v134
    v_and_b32 v205, 0xffff0000, v134
    v_lshlrev_b32 v206, 16, v135
    v_and_b32 v207, 0xffff0000, v135
    s_waitcnt lgkmcnt(1)
    v_pk_fma_f32 v[200:201], v[200:201], v[226:227], v[226:227] op_sel:[0,0,1] op_sel_hi:[1,0,1]
    v_pk_fma_f32 v[202:203], v[202:203], v[226:227], v[226:227] op_sel:[0,0,1] op_sel_hi:[1,0,1]
    v_pk_fma_f32 v[204:205], v[204:205], v[226:227], v[226:227] op_sel:[0,0,1] op_sel_hi:[1,0,1]
    v_pk_fma_f32 v[206:207], v[206:207], v[226:227], v[226:227] op_sel:[0,0,1] op_sel_hi:[1,0,1]
    ds_read_b64 v[224:225], v234 offset:64
    v_lshlrev_b32 v208, 16, v136
    v_and_b32 v209, 0xffff0000, v136
    v_lshlrev_b32 v210, 16, v137
    v_and_b32 v211, 0xffff0000, v137
    v_lshlrev_b32 v212, 16, v138
    v_and_b32 v213, 0xffff0000, v138
    v_lshlrev_b32 v214, 16, v139
    v_and_b32 v215, 0xffff0000, v139
    s_waitcnt lgkmcnt(1)
    v_pk_fma_f32 v[208:209], v[208:209], v[228:229], v[228:229] op_sel:[0,0,1] op_sel_hi:[1,0,1]
    v_pk_fma_f32 v[210:211], v[210:211], v[228:229], v[228:229] op_sel:[0,0,1] op_sel_hi:[1,0,1]
    v_pk_fma_f32 v[212:213], v[212:213], v[228:229], v[228:229] op_sel:[0,0,1] op_sel_hi:[1,0,1]
    v_pk_fma_f32 v[214:215], v[214:215], v[228:229], v[228:229] op_sel:[0,0,1] op_sel_hi:[1,0,1]
    v_lshlrev_b32 v216, 16, v140
    v_and_b32 v217, 0xffff0000, v140
    v_lshlrev_b32 v218, 16, v141
    v_and_b32 v219, 0xffff0000, v141
    v_lshlrev_b32 v220, 16, v142
    v_and_b32 v221, 0xffff0000, v142
    v_lshlrev_b32 v222, 16, v143
    v_and_b32 v223, 0xffff0000, v143
    s_waitcnt lgkmcnt(0)
    v_pk_fma_f32 v[216:217], v[216:217], v[224:225], v[224:225] op_sel:[0,0,1] op_sel_hi:[1,0,1]
    v_pk_fma_f32 v[218:219], v[218:219], v[224:225], v[224:225] op_sel:[0,0,1] op_sel_hi:[1,0,1]
    v_pk_fma_f32 v[220:221], v[220:221], v[224:225], v[224:225] op_sel:[0,0,1] op_sel_hi:[1,0,1]
    v_pk_fma_f32 v[222:223], v[222:223], v[224:225], v[224:225] op_sel:[0,0,1] op_sel_hi:[1,0,1]
    buffer_load_dwordx4 v[24:27], v20, s[4:7], s81 offen offset:0 sc1
    buffer_load_dwordx4 v[28:31], v20, s[4:7], s82 offen offset:0 sc1
    buffer_load_dwordx4 v[32:35], v20, s[4:7], s81 offen offset:1024 sc1
    buffer_load_dwordx4 v[36:39], v20, s[4:7], s82 offen offset:1024 sc1
    buffer_load_dwordx4 v[40:43], v20, s[4:7], s81 offen offset:2048 sc1
    buffer_load_dwordx4 v[44:47], v20, s[4:7], s82 offen offset:2048 sc1
    buffer_load_dwordx4 v[48:51], v20, s[4:7], s81 offen offset:3072 sc1
    buffer_load_dwordx4 v[52:55], v20, s[4:7], s82 offen offset:3072 sc1
    s_add_u32 s81, s81, 4096
    s_add_u32 s82, s82, 4096
    s_add_u32 s79, s79, 81920
    v_add_u32 v224, s79, v20
    s_cmp_ge_u32 s10, 5
    s_cbranch_scc1 L_p0_notab_234036
    s_waitcnt vmcnt(8)
    v_add_f32 v88, v88, v92
    v_add_f32 v96, v96, v100
    v_add_f32 v89, v89, v93
    v_add_f32 v97, v97, v101
    v_add_f32 v90, v90, v94
    v_add_f32 v98, v98, v102
    v_add_f32 v91, v91, v95
    v_add_f32 v99, v99, v103
    v_add_f32 v88, v88, v96
    v_add_f32 v89, v89, v97
    v_add_f32 v90, v90, v98
    v_add_f32 v91, v91, v99
    ds_write_b128 v224, v[88:91]
L_p0_notab_234036:
    s_waitcnt vmcnt(8) lgkmcnt(0)
    s_barrier
    ds_read_b128 v[104:107], v231 offset:2560
    ds_read_b128 v[112:115], v231 offset:0
    ds_read_b128 v[108:111], v231 offset:2576
    ds_read_b128 v[116:119], v231 offset:16
    ds_read_b128 v[120:123], v232 offset:2560
    ds_read_b128 v[128:131], v232 offset:0
    ds_read_b128 v[124:127], v232 offset:2576
    ds_read_b128 v[132:135], v232 offset:16
    s_waitcnt lgkmcnt(4)
    buffer_load_dwordx4 v[56:59], v20, s[4:7], s81 offen offset:0 sc1
    buffer_load_dwordx4 v[60:63], v20, s[4:7], s82 offen offset:0 sc1
    v_pk_fma_f32 v[144:145], v[144:145], v[104:105], v[112:113]
    v_pk_fma_f32 v[146:147], v[146:147], v[106:107], v[114:115]
    v_pk_fma_f32 v[148:149], v[148:149], v[108:109], v[116:117]
    v_pk_fma_f32 v[150:151], v[150:151], v[110:111], v[118:119]
    v_cvt_pk_bf16_f32 v144, v144, v145
    v_cvt_pk_bf16_f32 v145, v146, v147
    v_cvt_pk_bf16_f32 v146, v148, v149
    v_cvt_pk_bf16_f32 v147, v150, v151
    ds_write_b128 v19, v[144:147] offset:0
    buffer_load_dwordx4 v[64:67], v20, s[4:7], s81 offen offset:1024 sc1
    buffer_load_dwordx4 v[68:71], v20, s[4:7], s82 offen offset:1024 sc1
    v_pk_fma_f32 v[152:153], v[152:153], v[104:105], v[112:113]
    v_pk_fma_f32 v[154:155], v[154:155], v[106:107], v[114:115]
    v_pk_fma_f32 v[156:157], v[156:157], v[108:109], v[116:117]
    v_pk_fma_f32 v[158:159], v[158:159], v[110:111], v[118:119]
    v_cvt_pk_bf16_f32 v152, v152, v153
    v_cvt_pk_bf16_f32 v153, v154, v155
    v_cvt_pk_bf16_f32 v154, v156, v157
    v_cvt_pk_bf16_f32 v155, v158, v159
    ds_write_b128 v18, v[152:155] offset:0
    buffer_load_dwordx4 v[72:75], v20, s[4:7], s81 offen offset:2048 sc1
    buffer_load_dwordx4 v[76:79], v20, s[4:7], s82 offen offset:2048 sc1
    v_pk_fma_f32 v[160:161], v[160:161], v[104:105], v[112:113]
    v_pk_fma_f32 v[162:163], v[162:163], v[106:107], v[114:115]
    v_pk_fma_f32 v[164:165], v[164:165], v[108:109], v[116:117]
    v_pk_fma_f32 v[166:167], v[166:167], v[110:111], v[118:119]
    v_cvt_pk_bf16_f32 v160, v160, v161
    v_cvt_pk_bf16_f32 v161, v162, v163
    v_cvt_pk_bf16_f32 v162, v164, v165
    v_cvt_pk_bf16_f32 v163, v166, v167
    ds_write_b128 v19, v[160:163] offset:1024
    buffer_load_dwordx4 v[80:83], v20, s[4:7], s81 offen offset:3072 sc1
    buffer_load_dwordx4 v[84:87], v20, s[4:7], s82 offen offset:3072 sc1
    s_add_u32 s81, s81, 4096
    s_add_u32 s82, s82, 4096
    v_pk_fma_f32 v[168:169], v[168:169], v[104:105], v[112:113]
    v_pk_fma_f32 v[170:171], v[170:171], v[106:107], v[114:115]
    v_pk_fma_f32 v[172:173], v[172:173], v[108:109], v[116:117]
    v_pk_fma_f32 v[174:175], v[174:175], v[110:111], v[118:119]
    v_cvt_pk_bf16_f32 v168, v168, v169
    v_cvt_pk_bf16_f32 v169, v170, v171
    v_cvt_pk_bf16_f32 v170, v172, v173
    v_cvt_pk_bf16_f32 v171, v174, v175
    ds_write_b128 v18, v[168:171] offset:1024
    v_pk_fma_f32 v[176:177], v[176:177], v[104:105], v[112:113]
    v_pk_fma_f32 v[178:179], v[178:179], v[106:107], v[114:115]
    v_pk_fma_f32 v[180:181], v[180:181], v[108:109], v[116:117]
    v_pk_fma_f32 v[182:183], v[182:183], v[110:111], v[118:119]
    v_cvt_pk_bf16_f32 v176, v176, v177
    v_cvt_pk_bf16_f32 v177, v178, v179
    v_cvt_pk_bf16_f32 v178, v180, v181
    v_cvt_pk_bf16_f32 v179, v182, v183
    ds_write_b128 v19, v[176:179] offset:2048
    v_pk_fma_f32 v[184:185], v[184:185], v[104:105], v[112:113]
    v_pk_fma_f32 v[186:187], v[186:187], v[106:107], v[114:115]
    v_pk_fma_f32 v[188:189], v[188:189], v[108:109], v[116:117]
    v_pk_fma_f32 v[190:191], v[190:191], v[110:111], v[118:119]
    v_cvt_pk_bf16_f32 v184, v184, v185
    v_cvt_pk_bf16_f32 v185, v186, v187
    v_cvt_pk_bf16_f32 v186, v188, v189
    v_cvt_pk_bf16_f32 v187, v190, v191
    ds_write_b128 v18, v[184:187] offset:2048
    v_pk_fma_f32 v[192:193], v[192:193], v[104:105], v[112:113]
    v_pk_fma_f32 v[194:195], v[194:195], v[106:107], v[114:115]
    v_pk_fma_f32 v[196:197], v[196:197], v[108:109], v[116:117]
    v_pk_fma_f32 v[198:199], v[198:199], v[110:111], v[118:119]
    v_cvt_pk_bf16_f32 v192, v192, v193
    v_cvt_pk_bf16_f32 v193, v194, v195
    v_cvt_pk_bf16_f32 v194, v196, v197
    v_cvt_pk_bf16_f32 v195, v198, v199
    ds_write_b128 v19, v[192:195] offset:3072
    v_pk_fma_f32 v[200:201], v[200:201], v[104:105], v[112:113]
    v_pk_fma_f32 v[202:203], v[202:203], v[106:107], v[114:115]
    v_pk_fma_f32 v[204:205], v[204:205], v[108:109], v[116:117]
    v_pk_fma_f32 v[206:207], v[206:207], v[110:111], v[118:119]
    v_cvt_pk_bf16_f32 v200, v200, v201
    v_cvt_pk_bf16_f32 v201, v202, v203
    v_cvt_pk_bf16_f32 v202, v204, v205
    v_cvt_pk_bf16_f32 v203, v206, v207
    ds_write_b128 v18, v[200:203] offset:3072
    s_waitcnt lgkmcnt(8)
    v_pk_fma_f32 v[208:209], v[208:209], v[120:121], v[128:129]
    v_pk_fma_f32 v[210:211], v[210:211], v[122:123], v[130:131]
    v_pk_fma_f32 v[212:213], v[212:213], v[124:125], v[132:133]
    v_pk_fma_f32 v[214:215], v[214:215], v[126:127], v[134:135]
    v_cvt_pk_bf16_f32 v208, v208, v209
    v_cvt_pk_bf16_f32 v209, v210, v211
    v_cvt_pk_bf16_f32 v210, v212, v213
    v_cvt_pk_bf16_f32 v211, v214, v215
    v_mov_b32 v19, v17
    v_xor_b32 v18, 128, v17
    ds_write_b128 v19, v[208:211] offset:0
    v_pk_fma_f32 v[216:217], v[216:217], v[120:121], v[128:129]
    v_pk_fma_f32 v[218:219], v[218:219], v[122:123], v[130:131]
    v_pk_fma_f32 v[220:221], v[220:221], v[124:125], v[132:133]
    v_pk_fma_f32 v[222:223], v[222:223], v[126:127], v[134:135]
    v_cvt_pk_bf16_f32 v216, v216, v217
    v_cvt_pk_bf16_f32 v217, v218, v219
    v_cvt_pk_bf16_f32 v218, v220, v221
    v_cvt_pk_bf16_f32 v219, v222, v223
    ds_write_b128 v18, v[216:219] offset:0
    v_and_b32 v184, 15, v1
    v_lshrrev_b32 v185, 4, v1
    v_xor_b32 v18, v184, v185
    v_lshlrev_b32 v18, 4, v18
    v_lshl_add_u32 v18, v185, 8, v18
    v_xor_b32 v19, 192, v18
    s_waitcnt lgkmcnt(0)
    s_barrier
    s_cmp_ge_u32 s10, 5
    s_cbranch_scc1 L_qkv_v_234037
    ds_read_b128 v[104:107], v18 offset:0
    ds_read_b128 v[108:111], v18 offset:1024
    ds_read_b128 v[112:115], v18 offset:2048
    ds_read_b128 v[116:119], v18 offset:3072
    ds_read_b128 v[120:123], v19 offset:4096
    ds_read_b128 v[124:127], v19 offset:5120
    ds_read_b128 v[128:131], v19 offset:6144
    ds_read_b128 v[132:135], v19 offset:7168
    s_waitcnt vmcnt(14) lgkmcnt(4)
    v_mfma_f32_16x16x32_bf16 v[152:155], v[24:27], v[104:107], 0
    ds_read_b128 v[136:139], v18 offset:8192
    v_mfma_f32_16x16x32_bf16 v[168:171], v[28:31], v[104:107], 0
    v_mfma_f32_16x16x32_bf16 v[156:159], v[24:27], v[108:111], 0
    ds_read_b128 v[140:143], v18 offset:9216
    v_mfma_f32_16x16x32_bf16 v[172:175], v[28:31], v[108:111], 0
    buffer_load_dwordx4 v[88:91], v20, s[4:7], s81 offen offset:0 sc1
    buffer_load_dwordx4 v[92:95], v20, s[4:7], s82 offen offset:0 sc1
    v_mfma_f32_16x16x32_bf16 v[160:163], v[24:27], v[112:115], 0
    ds_read_b128 v[144:147], v18 offset:10240
    v_mfma_f32_16x16x32_bf16 v[176:179], v[28:31], v[112:115], 0
    v_mfma_f32_16x16x32_bf16 v[164:167], v[24:27], v[116:119], 0
    ds_read_b128 v[148:151], v18 offset:11264
    v_mfma_f32_16x16x32_bf16 v[180:183], v[28:31], v[116:119], 0
    s_waitcnt vmcnt(14) lgkmcnt(4)
    v_mfma_f32_16x16x32_bf16 v[152:155], v[32:35], v[120:123], v[152:155]
    ds_read_b128 v[104:107], v19 offset:12288
    v_mfma_f32_16x16x32_bf16 v[168:171], v[36:39], v[120:123], v[168:171]
    v_mfma_f32_16x16x32_bf16 v[156:159], v[32:35], v[124:127], v[156:159]
    ds_read_b128 v[108:111], v19 offset:13312
    v_mfma_f32_16x16x32_bf16 v[172:175], v[36:39], v[124:127], v[172:175]
    buffer_load_dwordx4 v[96:99], v20, s[4:7], s81 offen offset:1024 sc1
    buffer_load_dwordx4 v[100:103], v20, s[4:7], s82 offen offset:1024 sc1
    v_mfma_f32_16x16x32_bf16 v[160:163], v[32:35], v[128:131], v[160:163]
    ds_read_b128 v[112:115], v19 offset:14336
    v_mfma_f32_16x16x32_bf16 v[176:179], v[36:39], v[128:131], v[176:179]
    v_mfma_f32_16x16x32_bf16 v[164:167], v[32:35], v[132:135], v[164:167]
    ds_read_b128 v[116:119], v19 offset:15360
    v_mfma_f32_16x16x32_bf16 v[180:183], v[36:39], v[132:135], v[180:183]
    s_waitcnt vmcnt(14) lgkmcnt(4)
    v_mfma_f32_16x16x32_bf16 v[152:155], v[40:43], v[136:139], v[152:155]
    ds_read_b128 v[120:123], v18 offset:16384
    v_mfma_f32_16x16x32_bf16 v[168:171], v[44:47], v[136:139], v[168:171]
    v_mfma_f32_16x16x32_bf16 v[156:159], v[40:43], v[140:143], v[156:159]
    ds_read_b128 v[124:127], v18 offset:17408
    v_mfma_f32_16x16x32_bf16 v[172:175], v[44:47], v[140:143], v[172:175]
    buffer_load_dwordx4 v[24:27], v20, s[4:7], s81 offen offset:2048 sc1
    buffer_load_dwordx4 v[28:31], v20, s[4:7], s82 offen offset:2048 sc1
    v_mfma_f32_16x16x32_bf16 v[160:163], v[40:43], v[144:147], v[160:163]
    ds_read_b128 v[128:131], v18 offset:18432
    v_mfma_f32_16x16x32_bf16 v[176:179], v[44:47], v[144:147], v[176:179]
    v_mfma_f32_16x16x32_bf16 v[164:167], v[40:43], v[148:151], v[164:167]
    ds_read_b128 v[132:135], v18 offset:19456
    v_mfma_f32_16x16x32_bf16 v[180:183], v[44:47], v[148:151], v[180:183]
    s_waitcnt vmcnt(14) lgkmcnt(4)
    v_mfma_f32_16x16x32_bf16 v[152:155], v[48:51], v[104:107], v[152:155]
    ds_read_b128 v[136:139], v19 offset:20480
    v_mfma_f32_16x16x32_bf16 v[168:171], v[52:55], v[104:107], v[168:171]
    v_mfma_f32_16x16x32_bf16 v[156:159], v[48:51], v[108:111], v[156:159]
    ds_read_b128 v[140:143], v19 offset:21504
    v_mfma_f32_16x16x32_bf16 v[172:175], v[52:55], v[108:111], v[172:175]
    buffer_load_dwordx4 v[32:35], v20, s[4:7], s81 offen offset:3072 sc1
    buffer_load_dwordx4 v[36:39], v20, s[4:7], s82 offen offset:3072 sc1
    s_add_u32 s81, s81, 4096
    s_add_u32 s82, s82, 4096
    v_mfma_f32_16x16x32_bf16 v[160:163], v[48:51], v[112:115], v[160:163]
    ds_read_b128 v[144:147], v19 offset:22528
    v_mfma_f32_16x16x32_bf16 v[176:179], v[52:55], v[112:115], v[176:179]
    v_mfma_f32_16x16x32_bf16 v[164:167], v[48:51], v[116:119], v[164:167]
    ds_read_b128 v[148:151], v19 offset:23552
    v_mfma_f32_16x16x32_bf16 v[180:183], v[52:55], v[116:119], v[180:183]
    s_waitcnt vmcnt(14) lgkmcnt(4)
    v_mfma_f32_16x16x32_bf16 v[152:155], v[56:59], v[120:123], v[152:155]
    ds_read_b128 v[104:107], v18 offset:24576
    v_mfma_f32_16x16x32_bf16 v[168:171], v[60:63], v[120:123], v[168:171]
    v_mfma_f32_16x16x32_bf16 v[156:159], v[56:59], v[124:127], v[156:159]
    ds_read_b128 v[108:111], v18 offset:25600
    v_mfma_f32_16x16x32_bf16 v[172:175], v[60:63], v[124:127], v[172:175]
    buffer_load_dwordx4 v[40:43], v20, s[4:7], s81 offen offset:0 sc1
    buffer_load_dwordx4 v[44:47], v20, s[4:7], s82 offen offset:0 sc1
    v_mfma_f32_16x16x32_bf16 v[160:163], v[56:59], v[128:131], v[160:163]
    ds_read_b128 v[112:115], v18 offset:26624
    v_mfma_f32_16x16x32_bf16 v[176:179], v[60:63], v[128:131], v[176:179]
    v_mfma_f32_16x16x32_bf16 v[164:167], v[56:59], v[132:135], v[164:167]
    ds_read_b128 v[116:119], v18 offset:27648
    v_mfma_f32_16x16x32_bf16 v[180:183], v[60:63], v[132:135], v[180:183]
    s_waitcnt vmcnt(14) lgkmcnt(4)
    v_mfma_f32_16x16x32_bf16 v[152:155], v[64:67], v[136:139], v[152:155]
    ds_read_b128 v[120:123], v19 offset:28672
    v_mfma_f32_16x16x32_bf16 v[168:171], v[68:71], v[136:139], v[168:171]
    v_mfma_f32_16x16x32_bf16 v[156:159], v[64:67], v[140:143], v[156:159]
    ds_read_b128 v[124:127], v19 offset:29696
    v_mfma_f32_16x16x32_bf16 v[172:175], v[68:71], v[140:143], v[172:175]
    buffer_load_dwordx4 v[48:51], v20, s[4:7], s81 offen offset:1024 sc1
    buffer_load_dwordx4 v[52:55], v20, s[4:7], s82 offen offset:1024 sc1
    v_mfma_f32_16x16x32_bf16 v[160:163], v[64:67], v[144:147], v[160:163]
    ds_read_b128 v[128:131], v19 offset:30720
    v_mfma_f32_16x16x32_bf16 v[176:179], v[68:71], v[144:147], v[176:179]
    v_mfma_f32_16x16x32_bf16 v[164:167], v[64:67], v[148:151], v[164:167]
    ds_read_b128 v[132:135], v19 offset:31744
    v_mfma_f32_16x16x32_bf16 v[180:183], v[68:71], v[148:151], v[180:183]
    s_waitcnt vmcnt(14) lgkmcnt(4)
    v_mfma_f32_16x16x32_bf16 v[152:155], v[72:75], v[104:107], v[152:155]
    ds_read_b128 v[136:139], v18 offset:32768
    v_mfma_f32_16x16x32_bf16 v[168:171], v[76:79], v[104:107], v[168:171]
    v_mfma_f32_16x16x32_bf16 v[156:159], v[72:75], v[108:111], v[156:159]
    ds_read_b128 v[140:143], v18 offset:33792
    v_mfma_f32_16x16x32_bf16 v[172:175], v[76:79], v[108:111], v[172:175]
    buffer_load_dwordx4 v[56:59], v20, s[4:7], s81 offen offset:2048 sc1
    buffer_load_dwordx4 v[60:63], v20, s[4:7], s82 offen offset:2048 sc1
    v_mfma_f32_16x16x32_bf16 v[160:163], v[72:75], v[112:115], v[160:163]
    ds_read_b128 v[144:147], v18 offset:34816
    v_mfma_f32_16x16x32_bf16 v[176:179], v[76:79], v[112:115], v[176:179]
    v_mfma_f32_16x16x32_bf16 v[164:167], v[72:75], v[116:119], v[164:167]
    ds_read_b128 v[148:151], v18 offset:35840
    v_mfma_f32_16x16x32_bf16 v[180:183], v[76:79], v[116:119], v[180:183]
    s_waitcnt vmcnt(14) lgkmcnt(4)
    v_mfma_f32_16x16x32_bf16 v[152:155], v[80:83], v[120:123], v[152:155]
    ds_read_b128 v[104:107], v19 offset:36864
    v_mfma_f32_16x16x32_bf16 v[168:171], v[84:87], v[120:123], v[168:171]
    v_mfma_f32_16x16x32_bf16 v[156:159], v[80:83], v[124:127], v[156:159]
    ds_read_b128 v[108:111], v19 offset:37888
    v_mfma_f32_16x16x32_bf16 v[172:175], v[84:87], v[124:127], v[172:175]
    buffer_load_dwordx4 v[64:67], v20, s[4:7], s81 offen offset:3072 sc1
    buffer_load_dwordx4 v[68:71], v20, s[4:7], s82 offen offset:3072 sc1
    s_add_u32 s81, s81, 4096
    s_add_u32 s82, s82, 4096
    v_mfma_f32_16x16x32_bf16 v[160:163], v[80:83], v[128:131], v[160:163]
    ds_read_b128 v[112:115], v19 offset:38912
    v_mfma_f32_16x16x32_bf16 v[176:179], v[84:87], v[128:131], v[176:179]
    v_mfma_f32_16x16x32_bf16 v[164:167], v[80:83], v[132:135], v[164:167]
    ds_read_b128 v[116:119], v19 offset:39936
    v_mfma_f32_16x16x32_bf16 v[180:183], v[84:87], v[132:135], v[180:183]
    s_waitcnt vmcnt(14) lgkmcnt(4)
    v_mfma_f32_16x16x32_bf16 v[152:155], v[88:91], v[136:139], v[152:155]
    ds_read_b128 v[120:123], v18 offset:40960
    v_mfma_f32_16x16x32_bf16 v[168:171], v[92:95], v[136:139], v[168:171]
    v_mfma_f32_16x16x32_bf16 v[156:159], v[88:91], v[140:143], v[156:159]
    ds_read_b128 v[124:127], v18 offset:41984
    v_mfma_f32_16x16x32_bf16 v[172:175], v[92:95], v[140:143], v[172:175]
    buffer_load_dwordx4 v[72:75], v20, s[4:7], s81 offen offset:0 sc1
    buffer_load_dwordx4 v[76:79], v20, s[4:7], s82 offen offset:0 sc1
    v_mfma_f32_16x16x32_bf16 v[160:163], v[88:91], v[144:147], v[160:163]
    ds_read_b128 v[128:131], v18 offset:43008
    v_mfma_f32_16x16x32_bf16 v[176:179], v[92:95], v[144:147], v[176:179]
    v_mfma_f32_16x16x32_bf16 v[164:167], v[88:91], v[148:151], v[164:167]
    ds_read_b128 v[132:135], v18 offset:44032
    v_mfma_f32_16x16x32_bf16 v[180:183], v[92:95], v[148:151], v[180:183]
    s_waitcnt vmcnt(14) lgkmcnt(4)
    v_mfma_f32_16x16x32_bf16 v[152:155], v[96:99], v[104:107], v[152:155]
    ds_read_b128 v[136:139], v19 offset:45056
    v_mfma_f32_16x16x32_bf16 v[168:171], v[100:103], v[104:107], v[168:171]
    v_mfma_f32_16x16x32_bf16 v[156:159], v[96:99], v[108:111], v[156:159]
    ds_read_b128 v[140:143], v19 offset:46080
    v_mfma_f32_16x16x32_bf16 v[172:175], v[100:103], v[108:111], v[172:175]
    buffer_load_dwordx4 v[80:83], v20, s[4:7], s81 offen offset:1024 sc1
    buffer_load_dwordx4 v[84:87], v20, s[4:7], s82 offen offset:1024 sc1
    v_mfma_f32_16x16x32_bf16 v[160:163], v[96:99], v[112:115], v[160:163]
    ds_read_b128 v[144:147], v19 offset:47104
    v_mfma_f32_16x16x32_bf16 v[176:179], v[100:103], v[112:115], v[176:179]
    v_mfma_f32_16x16x32_bf16 v[164:167], v[96:99], v[116:119], v[164:167]
    ds_read_b128 v[148:151], v19 offset:48128
    v_mfma_f32_16x16x32_bf16 v[180:183], v[100:103], v[116:119], v[180:183]
    s_waitcnt vmcnt(14) lgkmcnt(4)
    v_mfma_f32_16x16x32_bf16 v[152:155], v[24:27], v[120:123], v[152:155]
    ds_read_b128 v[104:107], v18 offset:49152
    v_mfma_f32_16x16x32_bf16 v[168:171], v[28:31], v[120:123], v[168:171]
    v_mfma_f32_16x16x32_bf16 v[156:159], v[24:27], v[124:127], v[156:159]
    ds_read_b128 v[108:111], v18 offset:50176
    v_mfma_f32_16x16x32_bf16 v[172:175], v[28:31], v[124:127], v[172:175]
    buffer_load_dwordx4 v[88:91], v20, s[4:7], s81 offen offset:2048 sc1
    buffer_load_dwordx4 v[92:95], v20, s[4:7], s82 offen offset:2048 sc1
    v_mfma_f32_16x16x32_bf16 v[160:163], v[24:27], v[128:131], v[160:163]
    ds_read_b128 v[112:115], v18 offset:51200
    v_mfma_f32_16x16x32_bf16 v[176:179], v[28:31], v[128:131], v[176:179]
    v_mfma_f32_16x16x32_bf16 v[164:167], v[24:27], v[132:135], v[164:167]
    ds_read_b128 v[116:119], v18 offset:52224
    v_mfma_f32_16x16x32_bf16 v[180:183], v[28:31], v[132:135], v[180:183]
    s_waitcnt vmcnt(14) lgkmcnt(4)
    v_mfma_f32_16x16x32_bf16 v[152:155], v[32:35], v[136:139], v[152:155]
    ds_read_b128 v[120:123], v19 offset:53248
    v_mfma_f32_16x16x32_bf16 v[168:171], v[36:39], v[136:139], v[168:171]
    v_mfma_f32_16x16x32_bf16 v[156:159], v[32:35], v[140:143], v[156:159]
    ds_read_b128 v[124:127], v19 offset:54272
    v_mfma_f32_16x16x32_bf16 v[172:175], v[36:39], v[140:143], v[172:175]
    buffer_load_dwordx4 v[96:99], v20, s[4:7], s81 offen offset:3072 sc1
    buffer_load_dwordx4 v[100:103], v20, s[4:7], s82 offen offset:3072 sc1
    v_mfma_f32_16x16x32_bf16 v[160:163], v[32:35], v[144:147], v[160:163]
    ds_read_b128 v[128:131], v19 offset:55296
    v_mfma_f32_16x16x32_bf16 v[176:179], v[36:39], v[144:147], v[176:179]
    v_mfma_f32_16x16x32_bf16 v[164:167], v[32:35], v[148:151], v[164:167]
    ds_read_b128 v[132:135], v19 offset:56320
    v_mfma_f32_16x16x32_bf16 v[180:183], v[36:39], v[148:151], v[180:183]
    s_waitcnt vmcnt(14) lgkmcnt(4)
    v_mfma_f32_16x16x32_bf16 v[152:155], v[40:43], v[104:107], v[152:155]
    ds_read_b128 v[136:139], v18 offset:57344
    v_mfma_f32_16x16x32_bf16 v[168:171], v[44:47], v[104:107], v[168:171]
    v_mfma_f32_16x16x32_bf16 v[156:159], v[40:43], v[108:111], v[156:159]
    ds_read_b128 v[140:143], v18 offset:58368
    v_mfma_f32_16x16x32_bf16 v[172:175], v[44:47], v[108:111], v[172:175]
    v_mfma_f32_16x16x32_bf16 v[160:163], v[40:43], v[112:115], v[160:163]
    ds_read_b128 v[144:147], v18 offset:59392
    v_mfma_f32_16x16x32_bf16 v[176:179], v[44:47], v[112:115], v[176:179]
    v_mfma_f32_16x16x32_bf16 v[164:167], v[40:43], v[116:119], v[164:167]
    ds_read_b128 v[148:151], v18 offset:60416
    v_mfma_f32_16x16x32_bf16 v[180:183], v[44:47], v[116:119], v[180:183]
    s_waitcnt vmcnt(12) lgkmcnt(4)
    v_mfma_f32_16x16x32_bf16 v[152:155], v[48:51], v[120:123], v[152:155]
    ds_read_b128 v[104:107], v19 offset:61440
    v_mfma_f32_16x16x32_bf16 v[168:171], v[52:55], v[120:123], v[168:171]
    v_mfma_f32_16x16x32_bf16 v[156:159], v[48:51], v[124:127], v[156:159]
    ds_read_b128 v[108:111], v19 offset:62464
    v_mfma_f32_16x16x32_bf16 v[172:175], v[52:55], v[124:127], v[172:175]
    v_mfma_f32_16x16x32_bf16 v[160:163], v[48:51], v[128:131], v[160:163]
    ds_read_b128 v[112:115], v19 offset:63488
    v_mfma_f32_16x16x32_bf16 v[176:179], v[52:55], v[128:131], v[176:179]
    v_mfma_f32_16x16x32_bf16 v[164:167], v[48:51], v[132:135], v[164:167]
    ds_read_b128 v[116:119], v19 offset:64512
    v_mfma_f32_16x16x32_bf16 v[180:183], v[52:55], v[132:135], v[180:183]
    s_waitcnt vmcnt(10) lgkmcnt(4)
    v_add_u32 v18, 65536, v18
    v_mfma_f32_16x16x32_bf16 v[152:155], v[56:59], v[136:139], v[152:155]
    ds_read_b128 v[120:123], v18 offset:0
    v_mfma_f32_16x16x32_bf16 v[168:171], v[60:63], v[136:139], v[168:171]
    v_mfma_f32_16x16x32_bf16 v[156:159], v[56:59], v[140:143], v[156:159]
    ds_read_b128 v[124:127], v18 offset:1024
    v_mfma_f32_16x16x32_bf16 v[172:175], v[60:63], v[140:143], v[172:175]
    v_mfma_f32_16x16x32_bf16 v[160:163], v[56:59], v[144:147], v[160:163]
    ds_read_b128 v[128:131], v18 offset:2048
    v_mfma_f32_16x16x32_bf16 v[176:179], v[60:63], v[144:147], v[176:179]
    v_mfma_f32_16x16x32_bf16 v[164:167], v[56:59], v[148:151], v[164:167]
    ds_read_b128 v[132:135], v18 offset:3072
    v_mfma_f32_16x16x32_bf16 v[180:183], v[60:63], v[148:151], v[180:183]
    s_waitcnt vmcnt(8) lgkmcnt(4)
    v_add_u32 v19, 65536, v19
    v_mfma_f32_16x16x32_bf16 v[152:155], v[64:67], v[104:107], v[152:155]
    ds_read_b128 v[136:139], v19 offset:4096
    v_mfma_f32_16x16x32_bf16 v[168:171], v[68:71], v[104:107], v[168:171]
    v_mfma_f32_16x16x32_bf16 v[156:159], v[64:67], v[108:111], v[156:159]
    ds_read_b128 v[140:143], v19 offset:5120
    v_mfma_f32_16x16x32_bf16 v[172:175], v[68:71], v[108:111], v[172:175]
    v_mfma_f32_16x16x32_bf16 v[160:163], v[64:67], v[112:115], v[160:163]
    ds_read_b128 v[144:147], v19 offset:6144
    v_mfma_f32_16x16x32_bf16 v[176:179], v[68:71], v[112:115], v[176:179]
    v_mfma_f32_16x16x32_bf16 v[164:167], v[64:67], v[116:119], v[164:167]
    ds_read_b128 v[148:151], v19 offset:7168
    v_mfma_f32_16x16x32_bf16 v[180:183], v[68:71], v[116:119], v[180:183]
    s_waitcnt vmcnt(6) lgkmcnt(4)
    v_mfma_f32_16x16x32_bf16 v[152:155], v[72:75], v[120:123], v[152:155]
    ds_read_b128 v[104:107], v18 offset:8192
    v_mfma_f32_16x16x32_bf16 v[168:171], v[76:79], v[120:123], v[168:171]
    v_mfma_f32_16x16x32_bf16 v[156:159], v[72:75], v[124:127], v[156:159]
    ds_read_b128 v[108:111], v18 offset:9216
    v_mfma_f32_16x16x32_bf16 v[172:175], v[76:79], v[124:127], v[172:175]
    v_mfma_f32_16x16x32_bf16 v[160:163], v[72:75], v[128:131], v[160:163]
    ds_read_b128 v[112:115], v18 offset:10240
    v_mfma_f32_16x16x32_bf16 v[176:179], v[76:79], v[128:131], v[176:179]
    v_mfma_f32_16x16x32_bf16 v[164:167], v[72:75], v[132:135], v[164:167]
    ds_read_b128 v[116:119], v18 offset:11264
    v_mfma_f32_16x16x32_bf16 v[180:183], v[76:79], v[132:135], v[180:183]
    s_waitcnt vmcnt(4) lgkmcnt(4)
    v_mfma_f32_16x16x32_bf16 v[152:155], v[80:83], v[136:139], v[152:155]
    ds_read_b128 v[120:123], v19 offset:12288
    v_mfma_f32_16x16x32_bf16 v[168:171], v[84:87], v[136:139], v[168:171]
    v_mfma_f32_16x16x32_bf16 v[156:159], v[80:83], v[140:143], v[156:159]
    ds_read_b128 v[124:127], v19 offset:13312
    v_mfma_f32_16x16x32_bf16 v[172:175], v[84:87], v[140:143], v[172:175]
    v_mfma_f32_16x16x32_bf16 v[160:163], v[80:83], v[144:147], v[160:163]
    ds_read_b128 v[128:131], v19 offset:14336
    v_mfma_f32_16x16x32_bf16 v[176:179], v[84:87], v[144:147], v[176:179]
    v_mfma_f32_16x16x32_bf16 v[164:167], v[80:83], v[148:151], v[164:167]
    ds_read_b128 v[132:135], v19 offset:15360
    v_mfma_f32_16x16x32_bf16 v[180:183], v[84:87], v[148:151], v[180:183]
    s_waitcnt vmcnt(2) lgkmcnt(4)
    v_mfma_f32_16x16x32_bf16 v[152:155], v[88:91], v[104:107], v[152:155]
    v_mfma_f32_16x16x32_bf16 v[168:171], v[92:95], v[104:107], v[168:171]
    v_mfma_f32_16x16x32_bf16 v[156:159], v[88:91], v[108:111], v[156:159]
    v_mfma_f32_16x16x32_bf16 v[172:175], v[92:95], v[108:111], v[172:175]
    v_mfma_f32_16x16x32_bf16 v[160:163], v[88:91], v[112:115], v[160:163]
    v_mfma_f32_16x16x32_bf16 v[176:179], v[92:95], v[112:115], v[176:179]
    v_mfma_f32_16x16x32_bf16 v[164:167], v[88:91], v[116:119], v[164:167]
    v_mfma_f32_16x16x32_bf16 v[180:183], v[92:95], v[116:119], v[180:183]
    s_waitcnt vmcnt(0) lgkmcnt(0)
    v_mfma_f32_16x16x32_bf16 v[152:155], v[96:99], v[120:123], v[152:155]
    v_mfma_f32_16x16x32_bf16 v[168:171], v[100:103], v[120:123], v[168:171]
    v_mfma_f32_16x16x32_bf16 v[156:159], v[96:99], v[124:127], v[156:159]
    v_mfma_f32_16x16x32_bf16 v[172:175], v[100:103], v[124:127], v[172:175]
    v_mfma_f32_16x16x32_bf16 v[160:163], v[96:99], v[128:131], v[160:163]
    v_mfma_f32_16x16x32_bf16 v[176:179], v[100:103], v[128:131], v[176:179]
    v_mfma_f32_16x16x32_bf16 v[164:167], v[96:99], v[132:135], v[164:167]
    v_mfma_f32_16x16x32_bf16 v[180:183], v[100:103], v[132:135], v[180:183]
    s_nop 6
    v_bfe_u32 v16, v184, 2, 2
    v_and_b32 v17, 3, v184
    v_lshl_add_u32 v16, v16, 3, v17
    v_lshrrev_b32 v15, 1, v185
    v_lshl_add_u32 v16, v15, 2, v16
    v_and_b32 v17, 1, v185
    s_lshl_b32 s78, s77, 8
    s_lshl_b32 s79, s76, 1
    s_add_u32 s78, s78, s79
    s_cmp_eq_u32 s10, 4
    s_cbranch_scc1 L_qkv_st_left_234041
    s_cmp_ge_u32 s10, 2
    s_cbranch_scc1 L_qkv_st_k_234040
    s_lshl_b32 s79, s10, 7
    s_add_u32 s78, s78, s79
    s_mul_i32 s78, s78, 1280
    s_add_u32 s78, s78, 1376256
    v_mul_u32_u24 v15, 81920, v15
    v_lshl_add_u32 v15, v17, 9, v15
    v_lshl_add_u32 v15, v184, 4, v15
    s_mov_b32 s79, 0x3ea52b5c
    v_mul_f32 v152, s79, v152
    v_mul_f32 v153, s79, v153
    v_mul_f32 v154, s79, v154
    v_mul_f32 v155, s79, v155
    v_mul_f32 v156, s79, v156
    v_mul_f32 v157, s79, v157
    v_mul_f32 v158, s79, v158
    v_mul_f32 v159, s79, v159
    v_mul_f32 v160, s79, v160
    v_mul_f32 v161, s79, v161
    v_mul_f32 v162, s79, v162
    v_mul_f32 v163, s79, v163
    v_mul_f32 v164, s79, v164
    v_mul_f32 v165, s79, v165
    v_mul_f32 v166, s79, v166
    v_mul_f32 v167, s79, v167
    v_mul_f32 v168, s79, v168
    v_mul_f32 v169, s79, v169
    v_mul_f32 v170, s79, v170
    v_mul_f32 v171, s79, v171
    v_mul_f32 v172, s79, v172
    v_mul_f32 v173, s79, v173
    v_mul_f32 v174, s79, v174
    v_mul_f32 v175, s79, v175
    v_mul_f32 v176, s79, v176
    v_mul_f32 v177, s79, v177
    v_mul_f32 v178, s79, v178
    v_mul_f32 v179, s79, v179
    v_mul_f32 v180, s79, v180
    v_mul_f32 v181, s79, v181
    v_mul_f32 v182, s79, v182
    v_mul_f32 v183, s79, v183
    v_cvt_pk_bf16_f32 v104, v152, v153
    v_cvt_pk_bf16_f32 v105, v154, v155
    v_cvt_pk_bf16_f32 v106, v168, v169
    v_cvt_pk_bf16_f32 v107, v170, v171
    buffer_store_dwordx4 v[104:107], v15, s[4:7], s78 offen offset:0 sc1
    v_cvt_pk_bf16_f32 v108, v156, v157
    v_cvt_pk_bf16_f32 v109, v158, v159
    v_cvt_pk_bf16_f32 v110, v172, v173
    v_cvt_pk_bf16_f32 v111, v174, v175
    buffer_store_dwordx4 v[108:111], v15, s[4:7], s78 offen offset:256 sc1
    v_cvt_pk_bf16_f32 v112, v160, v161
    v_cvt_pk_bf16_f32 v113, v162, v163
    v_cvt_pk_bf16_f32 v114, v176, v177
    v_cvt_pk_bf16_f32 v115, v178, v179
    buffer_store_dwordx4 v[112:115], v15, s[4:7], s78 offen offset:1280 sc1
    v_cvt_pk_bf16_f32 v116, v164, v165
    v_cvt_pk_bf16_f32 v117, v166, v167
    v_cvt_pk_bf16_f32 v118, v180, v181
    v_cvt_pk_bf16_f32 v119, v182, v183
    buffer_store_dwordx4 v[116:119], v15, s[4:7], s78 offen offset:1536 sc1
    s_branch L_qkv_fin_234039
L_qkv_st_k_234040:
    s_lshl_b32 s78, s77, 6
    s_lshl_b32 s79, s76, 1
    s_add_u32 s78, s78, s79
    s_mul_i32 s78, s78, 10496
    s_add_u32 s78, s78, 3997696
    s_and_b32 s79, s10, 1
    s_lshl_b32 s79, s79, 11
    s_add_u32 s78, s78, s79
    v_lshlrev_b32 v15, 9, v17
    v_lshl_add_u32 v15, v16, 4, v15
    v_cvt_pk_bf16_f32 v104, v152, v153
    v_cvt_pk_bf16_f32 v105, v154, v155
    v_cvt_pk_bf16_f32 v106, v168, v169
    v_cvt_pk_bf16_f32 v107, v170, v171
    v_cvt_pk_bf16_f32 v108, v156, v157
    v_cvt_pk_bf16_f32 v109, v158, v159
    v_cvt_pk_bf16_f32 v110, v172, v173
    v_cvt_pk_bf16_f32 v111, v174, v175
    s_nop 0
    v_permlane32_swap_b32 v104, v108
    v_permlane32_swap_b32 v105, v109
    v_permlane32_swap_b32 v106, v110
    v_permlane32_swap_b32 v107, v111
    buffer_store_dwordx4 v[104:107], v15, s[4:7], s78 offen sc1
    buffer_store_dwordx4 v[108:111], v15, s[4:7], s78 offen offset:1024 sc1
    s_add_u32 s78, s78, 10496
    v_cvt_pk_bf16_f32 v112, v160, v161
    v_cvt_pk_bf16_f32 v113, v162, v163
    v_cvt_pk_bf16_f32 v114, v176, v177
    v_cvt_pk_bf16_f32 v115, v178, v179
    v_cvt_pk_bf16_f32 v116, v164, v165
    v_cvt_pk_bf16_f32 v117, v166, v167
    v_cvt_pk_bf16_f32 v118, v180, v181
    v_cvt_pk_bf16_f32 v119, v182, v183
    s_nop 0
    v_permlane32_swap_b32 v112, v116
    v_permlane32_swap_b32 v113, v117
    v_permlane32_swap_b32 v114, v118
    v_permlane32_swap_b32 v115, v119
    buffer_store_dwordx4 v[112:115], v15, s[4:7], s78 offen sc1
    buffer_store_dwordx4 v[116:119], v15, s[4:7], s78 offen offset:1024 sc1
    s_branch L_qkv_fin_234039
L_qkv_st_left_234041:
    s_lshl_b32 s88, s77, 6
    s_lshl_b32 s79, s76, 1
    s_add_u32 s88, s88, s79
    s_mul_i32 s88, s88, 10496
    s_add_u32 s88, s88, 4001792
    s_mul_i32 s78, s78, 1280
    s_add_u32 s78, s78, 1377280
    v_mul_u32_u24 v15, 81920, v185
    v_lshl_add_u32 v15, v184, 3, v15
    v_lshlrev_b32 v17, 8, v17
    v_lshl_add_u32 v17, v16, 3, v17
    s_mov_b32 s79, 0x3ea52b5c
    v_mul_f32 v152, s79, v152
    v_mul_f32 v153, s79, v153
    v_mul_f32 v154, s79, v154
    v_mul_f32 v155, s79, v155
    v_mul_f32 v156, s79, v156
    v_mul_f32 v157, s79, v157
    v_mul_f32 v158, s79, v158
    v_mul_f32 v159, s79, v159
    v_mul_f32 v160, s79, v160
    v_mul_f32 v161, s79, v161
    v_mul_f32 v162, s79, v162
    v_mul_f32 v163, s79, v163
    v_mul_f32 v164, s79, v164
    v_mul_f32 v165, s79, v165
    v_mul_f32 v166, s79, v166
    v_mul_f32 v167, s79, v167
    v_cvt_pk_bf16_f32 v104, v152, v153
    v_cvt_pk_bf16_f32 v105, v154, v155
    v_cvt_pk_bf16_f32 v106, v168, v169
    v_cvt_pk_bf16_f32 v107, v170, v171
    v_cvt_pk_bf16_f32 v108, v156, v157
    v_cvt_pk_bf16_f32 v109, v158, v159
    v_cvt_pk_bf16_f32 v110, v172, v173
    v_cvt_pk_bf16_f32 v111, v174, v175
    buffer_store_dwordx2 v[104:105], v15, s[4:7], s78 offen offset:0 sc1
    buffer_store_dwordx2 v[108:109], v15, s[4:7], s78 offen offset:128 sc1
    v_permlane32_swap_b32 v106, v110
    v_permlane32_swap_b32 v107, v111
    buffer_store_dwordx2 v[106:107], v17, s[4:7], s88 offen offset:0 sc1
    buffer_store_dwordx2 v[110:111], v17, s[4:7], s88 offen offset:512 sc1
    s_add_u32 s88, s88, 10496
    v_cvt_pk_bf16_f32 v112, v160, v161
    v_cvt_pk_bf16_f32 v113, v162, v163
    v_cvt_pk_bf16_f32 v114, v176, v177
    v_cvt_pk_bf16_f32 v115, v178, v179
    v_cvt_pk_bf16_f32 v116, v164, v165
    v_cvt_pk_bf16_f32 v117, v166, v167
    v_cvt_pk_bf16_f32 v118, v180, v181
    v_cvt_pk_bf16_f32 v119, v182, v183
    buffer_store_dwordx2 v[112:113], v15, s[4:7], s78 offen offset:1280 sc1
    buffer_store_dwordx2 v[116:117], v15, s[4:7], s78 offen offset:1408 sc1
    v_permlane32_swap_b32 v114, v118
    v_permlane32_swap_b32 v115, v119
    buffer_store_dwordx2 v[114:115], v17, s[4:7], s88 offen offset:0 sc1
    buffer_store_dwordx2 v[118:119], v17, s[4:7], s88 offen offset:512 sc1
    s_branch L_qkv_fin_234039
L_qkv_v_234037:
    s_cmp_eq_u32 s10, 7
    s_cbranch_scc1 L_qkv_v1_234038
    ds_read_b128 v[104:107], v18 offset:0
    ds_read_b128 v[108:111], v18 offset:1024
    ds_read_b128 v[112:115], v18 offset:2048
    ds_read_b128 v[116:119], v18 offset:3072
    ds_read_b128 v[120:123], v19 offset:4096
    ds_read_b128 v[124:127], v19 offset:5120
    ds_read_b128 v[128:131], v19 offset:6144
    ds_read_b128 v[132:135], v19 offset:7168
    s_waitcnt vmcnt(14) lgkmcnt(4)
    v_mfma_f32_16x16x32_bf16 v[152:155], v[104:107], v[24:27], 0
    ds_read_b128 v[136:139], v18 offset:8192
    v_mfma_f32_16x16x32_bf16 v[168:171], v[104:107], v[28:31], 0
    v_mfma_f32_16x16x32_bf16 v[156:159], v[108:111], v[24:27], 0
    ds_read_b128 v[140:143], v18 offset:9216
    v_mfma_f32_16x16x32_bf16 v[172:175], v[108:111], v[28:31], 0
    buffer_load_dwordx4 v[88:91], v20, s[4:7], s81 offen offset:0 sc1
    buffer_load_dwordx4 v[92:95], v20, s[4:7], s82 offen offset:0 sc1
    v_mfma_f32_16x16x32_bf16 v[160:163], v[112:115], v[24:27], 0
    ds_read_b128 v[144:147], v18 offset:10240
    v_mfma_f32_16x16x32_bf16 v[176:179], v[112:115], v[28:31], 0
    v_mfma_f32_16x16x32_bf16 v[164:167], v[116:119], v[24:27], 0
    ds_read_b128 v[148:151], v18 offset:11264
    v_mfma_f32_16x16x32_bf16 v[180:183], v[116:119], v[28:31], 0
    s_waitcnt vmcnt(14) lgkmcnt(4)
    v_mfma_f32_16x16x32_bf16 v[152:155], v[120:123], v[32:35], v[152:155]
    ds_read_b128 v[104:107], v19 offset:12288
    v_mfma_f32_16x16x32_bf16 v[168:171], v[120:123], v[36:39], v[168:171]
    v_mfma_f32_16x16x32_bf16 v[156:159], v[124:127], v[32:35], v[156:159]
    ds_read_b128 v[108:111], v19 offset:13312
    v_mfma_f32_16x16x32_bf16 v[172:175], v[124:127], v[36:39], v[172:175]
    buffer_load_dwordx4 v[96:99], v20, s[4:7], s81 offen offset:1024 sc1
    buffer_load_dwordx4 v[100:103], v20, s[4:7], s82 offen offset:1024 sc1
    v_mfma_f32_16x16x32_bf16 v[160:163], v[128:131], v[32:35], v[160:163]
    ds_read_b128 v[112:115], v19 offset:14336
    v_mfma_f32_16x16x32_bf16 v[176:179], v[128:131], v[36:39], v[176:179]
    v_mfma_f32_16x16x32_bf16 v[164:167], v[132:135], v[32:35], v[164:167]
    ds_read_b128 v[116:119], v19 offset:15360
    v_mfma_f32_16x16x32_bf16 v[180:183], v[132:135], v[36:39], v[180:183]
    s_waitcnt vmcnt(14) lgkmcnt(4)
    v_mfma_f32_16x16x32_bf16 v[152:155], v[136:139], v[40:43], v[152:155]
    ds_read_b128 v[120:123], v18 offset:16384
    v_mfma_f32_16x16x32_bf16 v[168:171], v[136:139], v[44:47], v[168:171]
    v_mfma_f32_16x16x32_bf16 v[156:159], v[140:143], v[40:43], v[156:159]
    ds_read_b128 v[124:127], v18 offset:17408
    v_mfma_f32_16x16x32_bf16 v[172:175], v[140:143], v[44:47], v[172:175]
    buffer_load_dwordx4 v[24:27], v20, s[4:7], s81 offen offset:2048 sc1
    buffer_load_dwordx4 v[28:31], v20, s[4:7], s82 offen offset:2048 sc1
    v_mfma_f32_16x16x32_bf16 v[160:163], v[144:147], v[40:43], v[160:163]
    ds_read_b128 v[128:131], v18 offset:18432
    v_mfma_f32_16x16x32_bf16 v[176:179], v[144:147], v[44:47], v[176:179]
    v_mfma_f32_16x16x32_bf16 v[164:167], v[148:151], v[40:43], v[164:167]
    ds_read_b128 v[132:135], v18 offset:19456
    v_mfma_f32_16x16x32_bf16 v[180:183], v[148:151], v[44:47], v[180:183]
    s_waitcnt vmcnt(14) lgkmcnt(4)
    v_mfma_f32_16x16x32_bf16 v[152:155], v[104:107], v[48:51], v[152:155]
    ds_read_b128 v[136:139], v19 offset:20480
    v_mfma_f32_16x16x32_bf16 v[168:171], v[104:107], v[52:55], v[168:171]
    v_mfma_f32_16x16x32_bf16 v[156:159], v[108:111], v[48:51], v[156:159]
    ds_read_b128 v[140:143], v19 offset:21504
    v_mfma_f32_16x16x32_bf16 v[172:175], v[108:111], v[52:55], v[172:175]
    buffer_load_dwordx4 v[32:35], v20, s[4:7], s81 offen offset:3072 sc1
    buffer_load_dwordx4 v[36:39], v20, s[4:7], s82 offen offset:3072 sc1
    s_add_u32 s81, s81, 4096
    s_add_u32 s82, s82, 4096
    v_mfma_f32_16x16x32_bf16 v[160:163], v[112:115], v[48:51], v[160:163]
    ds_read_b128 v[144:147], v19 offset:22528
    v_mfma_f32_16x16x32_bf16 v[176:179], v[112:115], v[52:55], v[176:179]
    v_mfma_f32_16x16x32_bf16 v[164:167], v[116:119], v[48:51], v[164:167]
    ds_read_b128 v[148:151], v19 offset:23552
    v_mfma_f32_16x16x32_bf16 v[180:183], v[116:119], v[52:55], v[180:183]
    s_waitcnt vmcnt(14) lgkmcnt(4)
    v_mfma_f32_16x16x32_bf16 v[152:155], v[120:123], v[56:59], v[152:155]
    ds_read_b128 v[104:107], v18 offset:24576
    v_mfma_f32_16x16x32_bf16 v[168:171], v[120:123], v[60:63], v[168:171]
    v_mfma_f32_16x16x32_bf16 v[156:159], v[124:127], v[56:59], v[156:159]
    ds_read_b128 v[108:111], v18 offset:25600
    v_mfma_f32_16x16x32_bf16 v[172:175], v[124:127], v[60:63], v[172:175]
    buffer_load_dwordx4 v[40:43], v20, s[4:7], s81 offen offset:0 sc1
    buffer_load_dwordx4 v[44:47], v20, s[4:7], s82 offen offset:0 sc1
    v_mfma_f32_16x16x32_bf16 v[160:163], v[128:131], v[56:59], v[160:163]
    ds_read_b128 v[112:115], v18 offset:26624
    v_mfma_f32_16x16x32_bf16 v[176:179], v[128:131], v[60:63], v[176:179]
    v_mfma_f32_16x16x32_bf16 v[164:167], v[132:135], v[56:59], v[164:167]
    ds_read_b128 v[116:119], v18 offset:27648
    v_mfma_f32_16x16x32_bf16 v[180:183], v[132:135], v[60:63], v[180:183]
    s_waitcnt vmcnt(14) lgkmcnt(4)
    v_mfma_f32_16x16x32_bf16 v[152:155], v[136:139], v[64:67], v[152:155]
    ds_read_b128 v[120:123], v19 offset:28672
    v_mfma_f32_16x16x32_bf16 v[168:171], v[136:139], v[68:71], v[168:171]
    v_mfma_f32_16x16x32_bf16 v[156:159], v[140:143], v[64:67], v[156:159]
    ds_read_b128 v[124:127], v19 offset:29696
    v_mfma_f32_16x16x32_bf16 v[172:175], v[140:143], v[68:71], v[172:175]
    buffer_load_dwordx4 v[48:51], v20, s[4:7], s81 offen offset:1024 sc1
    buffer_load_dwordx4 v[52:55], v20, s[4:7], s82 offen offset:1024 sc1
    v_mfma_f32_16x16x32_bf16 v[160:163], v[144:147], v[64:67], v[160:163]
    ds_read_b128 v[128:131], v19 offset:30720
    v_mfma_f32_16x16x32_bf16 v[176:179], v[144:147], v[68:71], v[176:179]
    v_mfma_f32_16x16x32_bf16 v[164:167], v[148:151], v[64:67], v[164:167]
    ds_read_b128 v[132:135], v19 offset:31744
    v_mfma_f32_16x16x32_bf16 v[180:183], v[148:151], v[68:71], v[180:183]
    s_waitcnt vmcnt(14) lgkmcnt(4)
    v_mfma_f32_16x16x32_bf16 v[152:155], v[104:107], v[72:75], v[152:155]
    ds_read_b128 v[136:139], v18 offset:32768
    v_mfma_f32_16x16x32_bf16 v[168:171], v[104:107], v[76:79], v[168:171]
    v_mfma_f32_16x16x32_bf16 v[156:159], v[108:111], v[72:75], v[156:159]
    ds_read_b128 v[140:143], v18 offset:33792
    v_mfma_f32_16x16x32_bf16 v[172:175], v[108:111], v[76:79], v[172:175]
    buffer_load_dwordx4 v[56:59], v20, s[4:7], s81 offen offset:2048 sc1
    buffer_load_dwordx4 v[60:63], v20, s[4:7], s82 offen offset:2048 sc1
    v_mfma_f32_16x16x32_bf16 v[160:163], v[112:115], v[72:75], v[160:163]
    ds_read_b128 v[144:147], v18 offset:34816
    v_mfma_f32_16x16x32_bf16 v[176:179], v[112:115], v[76:79], v[176:179]
    v_mfma_f32_16x16x32_bf16 v[164:167], v[116:119], v[72:75], v[164:167]
    ds_read_b128 v[148:151], v18 offset:35840
    v_mfma_f32_16x16x32_bf16 v[180:183], v[116:119], v[76:79], v[180:183]
    s_waitcnt vmcnt(14) lgkmcnt(4)
    v_mfma_f32_16x16x32_bf16 v[152:155], v[120:123], v[80:83], v[152:155]
    ds_read_b128 v[104:107], v19 offset:36864
    v_mfma_f32_16x16x32_bf16 v[168:171], v[120:123], v[84:87], v[168:171]
    v_mfma_f32_16x16x32_bf16 v[156:159], v[124:127], v[80:83], v[156:159]
    ds_read_b128 v[108:111], v19 offset:37888
    v_mfma_f32_16x16x32_bf16 v[172:175], v[124:127], v[84:87], v[172:175]
    buffer_load_dwordx4 v[64:67], v20, s[4:7], s81 offen offset:3072 sc1
    buffer_load_dwordx4 v[68:71], v20, s[4:7], s82 offen offset:3072 sc1
    s_add_u32 s81, s81, 4096
    s_add_u32 s82, s82, 4096
    v_mfma_f32_16x16x32_bf16 v[160:163], v[128:131], v[80:83], v[160:163]
    ds_read_b128 v[112:115], v19 offset:38912
    v_mfma_f32_16x16x32_bf16 v[176:179], v[128:131], v[84:87], v[176:179]
    v_mfma_f32_16x16x32_bf16 v[164:167], v[132:135], v[80:83], v[164:167]
    ds_read_b128 v[116:119], v19 offset:39936
    v_mfma_f32_16x16x32_bf16 v[180:183], v[132:135], v[84:87], v[180:183]
    s_waitcnt vmcnt(14) lgkmcnt(4)
    v_mfma_f32_16x16x32_bf16 v[152:155], v[136:139], v[88:91], v[152:155]
    ds_read_b128 v[120:123], v18 offset:40960
    v_mfma_f32_16x16x32_bf16 v[168:171], v[136:139], v[92:95], v[168:171]
    v_mfma_f32_16x16x32_bf16 v[156:159], v[140:143], v[88:91], v[156:159]
    ds_read_b128 v[124:127], v18 offset:41984
    v_mfma_f32_16x16x32_bf16 v[172:175], v[140:143], v[92:95], v[172:175]
    buffer_load_dwordx4 v[72:75], v20, s[4:7], s81 offen offset:0 sc1
    buffer_load_dwordx4 v[76:79], v20, s[4:7], s82 offen offset:0 sc1
    v_mfma_f32_16x16x32_bf16 v[160:163], v[144:147], v[88:91], v[160:163]
    ds_read_b128 v[128:131], v18 offset:43008
    v_mfma_f32_16x16x32_bf16 v[176:179], v[144:147], v[92:95], v[176:179]
    v_mfma_f32_16x16x32_bf16 v[164:167], v[148:151], v[88:91], v[164:167]
    ds_read_b128 v[132:135], v18 offset:44032
    v_mfma_f32_16x16x32_bf16 v[180:183], v[148:151], v[92:95], v[180:183]
    s_waitcnt vmcnt(14) lgkmcnt(4)
    v_mfma_f32_16x16x32_bf16 v[152:155], v[104:107], v[96:99], v[152:155]
    ds_read_b128 v[136:139], v19 offset:45056
    v_mfma_f32_16x16x32_bf16 v[168:171], v[104:107], v[100:103], v[168:171]
    v_mfma_f32_16x16x32_bf16 v[156:159], v[108:111], v[96:99], v[156:159]
    ds_read_b128 v[140:143], v19 offset:46080
    v_mfma_f32_16x16x32_bf16 v[172:175], v[108:111], v[100:103], v[172:175]
    buffer_load_dwordx4 v[80:83], v20, s[4:7], s81 offen offset:1024 sc1
    buffer_load_dwordx4 v[84:87], v20, s[4:7], s82 offen offset:1024 sc1
    v_mfma_f32_16x16x32_bf16 v[160:163], v[112:115], v[96:99], v[160:163]
    ds_read_b128 v[144:147], v19 offset:47104
    v_mfma_f32_16x16x32_bf16 v[176:179], v[112:115], v[100:103], v[176:179]
    v_mfma_f32_16x16x32_bf16 v[164:167], v[116:119], v[96:99], v[164:167]
    ds_read_b128 v[148:151], v19 offset:48128
    v_mfma_f32_16x16x32_bf16 v[180:183], v[116:119], v[100:103], v[180:183]
    s_waitcnt vmcnt(14) lgkmcnt(4)
    v_mfma_f32_16x16x32_bf16 v[152:155], v[120:123], v[24:27], v[152:155]
    ds_read_b128 v[104:107], v18 offset:49152
    v_mfma_f32_16x16x32_bf16 v[168:171], v[120:123], v[28:31], v[168:171]
    v_mfma_f32_16x16x32_bf16 v[156:159], v[124:127], v[24:27], v[156:159]
    ds_read_b128 v[108:111], v18 offset:50176
    v_mfma_f32_16x16x32_bf16 v[172:175], v[124:127], v[28:31], v[172:175]
    buffer_load_dwordx4 v[88:91], v20, s[4:7], s81 offen offset:2048 sc1
    buffer_load_dwordx4 v[92:95], v20, s[4:7], s82 offen offset:2048 sc1
    v_mfma_f32_16x16x32_bf16 v[160:163], v[128:131], v[24:27], v[160:163]
    ds_read_b128 v[112:115], v18 offset:51200
    v_mfma_f32_16x16x32_bf16 v[176:179], v[128:131], v[28:31], v[176:179]
    v_mfma_f32_16x16x32_bf16 v[164:167], v[132:135], v[24:27], v[164:167]
    ds_read_b128 v[116:119], v18 offset:52224
    v_mfma_f32_16x16x32_bf16 v[180:183], v[132:135], v[28:31], v[180:183]
    s_waitcnt vmcnt(14) lgkmcnt(4)
    v_mfma_f32_16x16x32_bf16 v[152:155], v[136:139], v[32:35], v[152:155]
    ds_read_b128 v[120:123], v19 offset:53248
    v_mfma_f32_16x16x32_bf16 v[168:171], v[136:139], v[36:39], v[168:171]
    v_mfma_f32_16x16x32_bf16 v[156:159], v[140:143], v[32:35], v[156:159]
    ds_read_b128 v[124:127], v19 offset:54272
    v_mfma_f32_16x16x32_bf16 v[172:175], v[140:143], v[36:39], v[172:175]
    buffer_load_dwordx4 v[96:99], v20, s[4:7], s81 offen offset:3072 sc1
    buffer_load_dwordx4 v[100:103], v20, s[4:7], s82 offen offset:3072 sc1
    v_mfma_f32_16x16x32_bf16 v[160:163], v[144:147], v[32:35], v[160:163]
    ds_read_b128 v[128:131], v19 offset:55296
    v_mfma_f32_16x16x32_bf16 v[176:179], v[144:147], v[36:39], v[176:179]
    v_mfma_f32_16x16x32_bf16 v[164:167], v[148:151], v[32:35], v[164:167]
    ds_read_b128 v[132:135], v19 offset:56320
    v_mfma_f32_16x16x32_bf16 v[180:183], v[148:151], v[36:39], v[180:183]
    s_waitcnt vmcnt(14) lgkmcnt(4)
    v_mfma_f32_16x16x32_bf16 v[152:155], v[104:107], v[40:43], v[152:155]
    ds_read_b128 v[136:139], v18 offset:57344
    v_mfma_f32_16x16x32_bf16 v[168:171], v[104:107], v[44:47], v[168:171]
    v_mfma_f32_16x16x32_bf16 v[156:159], v[108:111], v[40:43], v[156:159]
    ds_read_b128 v[140:143], v18 offset:58368
    v_mfma_f32_16x16x32_bf16 v[172:175], v[108:111], v[44:47], v[172:175]
    v_mfma_f32_16x16x32_bf16 v[160:163], v[112:115], v[40:43], v[160:163]
    ds_read_b128 v[144:147], v18 offset:59392
    v_mfma_f32_16x16x32_bf16 v[176:179], v[112:115], v[44:47], v[176:179]
    v_mfma_f32_16x16x32_bf16 v[164:167], v[116:119], v[40:43], v[164:167]
    ds_read_b128 v[148:151], v18 offset:60416
    v_mfma_f32_16x16x32_bf16 v[180:183], v[116:119], v[44:47], v[180:183]
    s_waitcnt vmcnt(12) lgkmcnt(4)
    v_mfma_f32_16x16x32_bf16 v[152:155], v[120:123], v[48:51], v[152:155]
    ds_read_b128 v[104:107], v19 offset:61440
    v_mfma_f32_16x16x32_bf16 v[168:171], v[120:123], v[52:55], v[168:171]
    v_mfma_f32_16x16x32_bf16 v[156:159], v[124:127], v[48:51], v[156:159]
    ds_read_b128 v[108:111], v19 offset:62464
    v_mfma_f32_16x16x32_bf16 v[172:175], v[124:127], v[52:55], v[172:175]
    v_mfma_f32_16x16x32_bf16 v[160:163], v[128:131], v[48:51], v[160:163]
    ds_read_b128 v[112:115], v19 offset:63488
    v_mfma_f32_16x16x32_bf16 v[176:179], v[128:131], v[52:55], v[176:179]
    v_mfma_f32_16x16x32_bf16 v[164:167], v[132:135], v[48:51], v[164:167]
    ds_read_b128 v[116:119], v19 offset:64512
    v_mfma_f32_16x16x32_bf16 v[180:183], v[132:135], v[52:55], v[180:183]
    s_waitcnt vmcnt(10) lgkmcnt(4)
    v_add_u32 v18, 65536, v18
    v_mfma_f32_16x16x32_bf16 v[152:155], v[136:139], v[56:59], v[152:155]
    ds_read_b128 v[120:123], v18 offset:0
    v_mfma_f32_16x16x32_bf16 v[168:171], v[136:139], v[60:63], v[168:171]
    v_mfma_f32_16x16x32_bf16 v[156:159], v[140:143], v[56:59], v[156:159]
    ds_read_b128 v[124:127], v18 offset:1024
    v_mfma_f32_16x16x32_bf16 v[172:175], v[140:143], v[60:63], v[172:175]
    v_mfma_f32_16x16x32_bf16 v[160:163], v[144:147], v[56:59], v[160:163]
    ds_read_b128 v[128:131], v18 offset:2048
    v_mfma_f32_16x16x32_bf16 v[176:179], v[144:147], v[60:63], v[176:179]
    v_mfma_f32_16x16x32_bf16 v[164:167], v[148:151], v[56:59], v[164:167]
    ds_read_b128 v[132:135], v18 offset:3072
    v_mfma_f32_16x16x32_bf16 v[180:183], v[148:151], v[60:63], v[180:183]
    s_waitcnt vmcnt(8) lgkmcnt(4)
    v_add_u32 v19, 65536, v19
    v_mfma_f32_16x16x32_bf16 v[152:155], v[104:107], v[64:67], v[152:155]
    ds_read_b128 v[136:139], v19 offset:4096
    v_mfma_f32_16x16x32_bf16 v[168:171], v[104:107], v[68:71], v[168:171]
    v_mfma_f32_16x16x32_bf16 v[156:159], v[108:111], v[64:67], v[156:159]
    ds_read_b128 v[140:143], v19 offset:5120
    v_mfma_f32_16x16x32_bf16 v[172:175], v[108:111], v[68:71], v[172:175]
    v_mfma_f32_16x16x32_bf16 v[160:163], v[112:115], v[64:67], v[160:163]
    ds_read_b128 v[144:147], v19 offset:6144
    v_mfma_f32_16x16x32_bf16 v[176:179], v[112:115], v[68:71], v[176:179]
    v_mfma_f32_16x16x32_bf16 v[164:167], v[116:119], v[64:67], v[164:167]
    ds_read_b128 v[148:151], v19 offset:7168
    v_mfma_f32_16x16x32_bf16 v[180:183], v[116:119], v[68:71], v[180:183]
    s_waitcnt vmcnt(6) lgkmcnt(4)
    v_mfma_f32_16x16x32_bf16 v[152:155], v[120:123], v[72:75], v[152:155]
    ds_read_b128 v[104:107], v18 offset:8192
    v_mfma_f32_16x16x32_bf16 v[168:171], v[120:123], v[76:79], v[168:171]
    v_mfma_f32_16x16x32_bf16 v[156:159], v[124:127], v[72:75], v[156:159]
    ds_read_b128 v[108:111], v18 offset:9216
    v_mfma_f32_16x16x32_bf16 v[172:175], v[124:127], v[76:79], v[172:175]
    v_mfma_f32_16x16x32_bf16 v[160:163], v[128:131], v[72:75], v[160:163]
    ds_read_b128 v[112:115], v18 offset:10240
    v_mfma_f32_16x16x32_bf16 v[176:179], v[128:131], v[76:79], v[176:179]
    v_mfma_f32_16x16x32_bf16 v[164:167], v[132:135], v[72:75], v[164:167]
    ds_read_b128 v[116:119], v18 offset:11264
    v_mfma_f32_16x16x32_bf16 v[180:183], v[132:135], v[76:79], v[180:183]
    s_waitcnt vmcnt(4) lgkmcnt(4)
    v_mfma_f32_16x16x32_bf16 v[152:155], v[136:139], v[80:83], v[152:155]
    ds_read_b128 v[120:123], v19 offset:12288
    v_mfma_f32_16x16x32_bf16 v[168:171], v[136:139], v[84:87], v[168:171]
    v_mfma_f32_16x16x32_bf16 v[156:159], v[140:143], v[80:83], v[156:159]
    ds_read_b128 v[124:127], v19 offset:13312
    v_mfma_f32_16x16x32_bf16 v[172:175], v[140:143], v[84:87], v[172:175]
    v_mfma_f32_16x16x32_bf16 v[160:163], v[144:147], v[80:83], v[160:163]
    ds_read_b128 v[128:131], v19 offset:14336
    v_mfma_f32_16x16x32_bf16 v[176:179], v[144:147], v[84:87], v[176:179]
    v_mfma_f32_16x16x32_bf16 v[164:167], v[148:151], v[80:83], v[164:167]
    ds_read_b128 v[132:135], v19 offset:15360
    v_mfma_f32_16x16x32_bf16 v[180:183], v[148:151], v[84:87], v[180:183]
    s_waitcnt vmcnt(2) lgkmcnt(4)
    v_mfma_f32_16x16x32_bf16 v[152:155], v[104:107], v[88:91], v[152:155]
    v_mfma_f32_16x16x32_bf16 v[168:171], v[104:107], v[92:95], v[168:171]
    v_mfma_f32_16x16x32_bf16 v[156:159], v[108:111], v[88:91], v[156:159]
    v_mfma_f32_16x16x32_bf16 v[172:175], v[108:111], v[92:95], v[172:175]
    v_mfma_f32_16x16x32_bf16 v[160:163], v[112:115], v[88:91], v[160:163]
    v_mfma_f32_16x16x32_bf16 v[176:179], v[112:115], v[92:95], v[176:179]
    v_mfma_f32_16x16x32_bf16 v[164:167], v[116:119], v[88:91], v[164:167]
    v_mfma_f32_16x16x32_bf16 v[180:183], v[116:119], v[92:95], v[180:183]
    s_waitcnt vmcnt(0) lgkmcnt(0)
    v_mfma_f32_16x16x32_bf16 v[152:155], v[120:123], v[96:99], v[152:155]
    v_mfma_f32_16x16x32_bf16 v[168:171], v[120:123], v[100:103], v[168:171]
    v_mfma_f32_16x16x32_bf16 v[156:159], v[124:127], v[96:99], v[156:159]
    v_mfma_f32_16x16x32_bf16 v[172:175], v[124:127], v[100:103], v[172:175]
    v_mfma_f32_16x16x32_bf16 v[160:163], v[128:131], v[96:99], v[160:163]
    v_mfma_f32_16x16x32_bf16 v[176:179], v[128:131], v[100:103], v[176:179]
    v_mfma_f32_16x16x32_bf16 v[164:167], v[132:135], v[96:99], v[164:167]
    v_mfma_f32_16x16x32_bf16 v[180:183], v[132:135], v[100:103], v[180:183]
    s_nop 6
    s_lshl_b32 s78, s77, 6
    s_lshl_b32 s79, s76, 1
    s_add_u32 s78, s78, s79
    s_mul_i32 s78, s78, 10496
    s_add_u32 s78, s78, 4002816
    s_sub_u32 s79, s10, 5
    s_lshl_b32 s79, s79, 9
    s_add_u32 s78, s78, s79
    s_add_u32 s88, s78, 10496
    v_mul_u32_u24 v15, 1280, v185
    v_lshl_add_u32 v15, v184, 4, v15
    v_cvt_pk_bf16_f32 v104, v152, v153
    v_cvt_pk_bf16_f32 v105, v154, v155
    v_cvt_pk_bf16_f32 v106, v156, v157
    v_cvt_pk_bf16_f32 v107, v158, v159
    buffer_store_dwordx4 v[104:107], v15, s[4:7], s78 offen offset:0 sc1
    v_cvt_pk_bf16_f32 v108, v160, v161
    v_cvt_pk_bf16_f32 v109, v162, v163
    v_cvt_pk_bf16_f32 v110, v164, v165
    v_cvt_pk_bf16_f32 v111, v166, v167
    buffer_store_dwordx4 v[108:111], v15, s[4:7], s88 offen offset:0 sc1
    v_cvt_pk_bf16_f32 v112, v168, v169
    v_cvt_pk_bf16_f32 v113, v170, v171
    v_cvt_pk_bf16_f32 v114, v172, v173
    v_cvt_pk_bf16_f32 v115, v174, v175
    buffer_store_dwordx4 v[112:115], v15, s[4:7], s78 offen offset:256 sc1
    v_cvt_pk_bf16_f32 v116, v176, v177
    v_cvt_pk_bf16_f32 v117, v178, v179
    v_cvt_pk_bf16_f32 v118, v180, v181
    v_cvt_pk_bf16_f32 v119, v182, v183
    buffer_store_dwordx4 v[116:119], v15, s[4:7], s88 offen offset:256 sc1
    s_branch L_qkv_fin_234039
L_qkv_v1_234038:
    ds_read_b128 v[104:107], v18 offset:0
    ds_read_b128 v[108:111], v18 offset:1024
    ds_read_b128 v[112:115], v18 offset:2048
    ds_read_b128 v[116:119], v18 offset:3072
    ds_read_b128 v[120:123], v19 offset:4096
    ds_read_b128 v[124:127], v19 offset:5120
    ds_read_b128 v[128:131], v19 offset:6144
    ds_read_b128 v[132:135], v19 offset:7168
    s_waitcnt vmcnt(14) lgkmcnt(4)
    v_mfma_f32_16x16x32_bf16 v[152:155], v[104:107], v[24:27], 0
    ds_read_b128 v[136:139], v18 offset:8192
    v_mfma_f32_16x16x32_bf16 v[156:159], v[108:111], v[24:27], 0
    ds_read_b128 v[140:143], v18 offset:9216
    buffer_load_dwordx4 v[88:91], v20, s[4:7], s81 offen offset:0 sc1
    buffer_load_dwordx4 v[92:95], v20, s[4:7], s82 offen offset:0 sc1
    v_mfma_f32_16x16x32_bf16 v[160:163], v[112:115], v[24:27], 0
    ds_read_b128 v[144:147], v18 offset:10240
    v_mfma_f32_16x16x32_bf16 v[164:167], v[116:119], v[24:27], 0
    ds_read_b128 v[148:151], v18 offset:11264
    s_waitcnt vmcnt(14) lgkmcnt(4)
    v_mfma_f32_16x16x32_bf16 v[152:155], v[120:123], v[32:35], v[152:155]
    ds_read_b128 v[104:107], v19 offset:12288
    v_mfma_f32_16x16x32_bf16 v[156:159], v[124:127], v[32:35], v[156:159]
    ds_read_b128 v[108:111], v19 offset:13312
    buffer_load_dwordx4 v[96:99], v20, s[4:7], s81 offen offset:1024 sc1
    buffer_load_dwordx4 v[100:103], v20, s[4:7], s82 offen offset:1024 sc1
    v_mfma_f32_16x16x32_bf16 v[160:163], v[128:131], v[32:35], v[160:163]
    ds_read_b128 v[112:115], v19 offset:14336
    v_mfma_f32_16x16x32_bf16 v[164:167], v[132:135], v[32:35], v[164:167]
    ds_read_b128 v[116:119], v19 offset:15360
    s_waitcnt vmcnt(14) lgkmcnt(4)
    v_mfma_f32_16x16x32_bf16 v[152:155], v[136:139], v[40:43], v[152:155]
    ds_read_b128 v[120:123], v18 offset:16384
    v_mfma_f32_16x16x32_bf16 v[156:159], v[140:143], v[40:43], v[156:159]
    ds_read_b128 v[124:127], v18 offset:17408
    buffer_load_dwordx4 v[24:27], v20, s[4:7], s81 offen offset:2048 sc1
    buffer_load_dwordx4 v[28:31], v20, s[4:7], s82 offen offset:2048 sc1
    v_mfma_f32_16x16x32_bf16 v[160:163], v[144:147], v[40:43], v[160:163]
    ds_read_b128 v[128:131], v18 offset:18432
    v_mfma_f32_16x16x32_bf16 v[164:167], v[148:151], v[40:43], v[164:167]
    ds_read_b128 v[132:135], v18 offset:19456
    s_waitcnt vmcnt(14) lgkmcnt(4)
    v_mfma_f32_16x16x32_bf16 v[152:155], v[104:107], v[48:51], v[152:155]
    ds_read_b128 v[136:139], v19 offset:20480
    v_mfma_f32_16x16x32_bf16 v[156:159], v[108:111], v[48:51], v[156:159]
    ds_read_b128 v[140:143], v19 offset:21504
    buffer_load_dwordx4 v[32:35], v20, s[4:7], s81 offen offset:3072 sc1
    buffer_load_dwordx4 v[36:39], v20, s[4:7], s82 offen offset:3072 sc1
    s_add_u32 s81, s81, 4096
    s_add_u32 s82, s82, 4096
    v_mfma_f32_16x16x32_bf16 v[160:163], v[112:115], v[48:51], v[160:163]
    ds_read_b128 v[144:147], v19 offset:22528
    v_mfma_f32_16x16x32_bf16 v[164:167], v[116:119], v[48:51], v[164:167]
    ds_read_b128 v[148:151], v19 offset:23552
    s_waitcnt vmcnt(14) lgkmcnt(4)
    v_mfma_f32_16x16x32_bf16 v[152:155], v[120:123], v[56:59], v[152:155]
    ds_read_b128 v[104:107], v18 offset:24576
    v_mfma_f32_16x16x32_bf16 v[156:159], v[124:127], v[56:59], v[156:159]
    ds_read_b128 v[108:111], v18 offset:25600
    buffer_load_dwordx4 v[40:43], v20, s[4:7], s81 offen offset:0 sc1
    buffer_load_dwordx4 v[44:47], v20, s[4:7], s82 offen offset:0 sc1
    v_mfma_f32_16x16x32_bf16 v[160:163], v[128:131], v[56:59], v[160:163]
    ds_read_b128 v[112:115], v18 offset:26624
    v_mfma_f32_16x16x32_bf16 v[164:167], v[132:135], v[56:59], v[164:167]
    ds_read_b128 v[116:119], v18 offset:27648
    s_waitcnt vmcnt(14) lgkmcnt(4)
    v_mfma_f32_16x16x32_bf16 v[152:155], v[136:139], v[64:67], v[152:155]
    ds_read_b128 v[120:123], v19 offset:28672
    v_mfma_f32_16x16x32_bf16 v[156:159], v[140:143], v[64:67], v[156:159]
    ds_read_b128 v[124:127], v19 offset:29696
    buffer_load_dwordx4 v[48:51], v20, s[4:7], s81 offen offset:1024 sc1
    buffer_load_dwordx4 v[52:55], v20, s[4:7], s82 offen offset:1024 sc1
    v_mfma_f32_16x16x32_bf16 v[160:163], v[144:147], v[64:67], v[160:163]
    ds_read_b128 v[128:131], v19 offset:30720
    v_mfma_f32_16x16x32_bf16 v[164:167], v[148:151], v[64:67], v[164:167]
    ds_read_b128 v[132:135], v19 offset:31744
    s_waitcnt vmcnt(14) lgkmcnt(4)
    v_mfma_f32_16x16x32_bf16 v[152:155], v[104:107], v[72:75], v[152:155]
    ds_read_b128 v[136:139], v18 offset:32768
    v_mfma_f32_16x16x32_bf16 v[156:159], v[108:111], v[72:75], v[156:159]
    ds_read_b128 v[140:143], v18 offset:33792
    buffer_load_dwordx4 v[56:59], v20, s[4:7], s81 offen offset:2048 sc1
    buffer_load_dwordx4 v[60:63], v20, s[4:7], s82 offen offset:2048 sc1
    v_mfma_f32_16x16x32_bf16 v[160:163], v[112:115], v[72:75], v[160:163]
    ds_read_b128 v[144:147], v18 offset:34816
    v_mfma_f32_16x16x32_bf16 v[164:167], v[116:119], v[72:75], v[164:167]
    ds_read_b128 v[148:151], v18 offset:35840
    s_waitcnt vmcnt(14) lgkmcnt(4)
    v_mfma_f32_16x16x32_bf16 v[152:155], v[120:123], v[80:83], v[152:155]
    ds_read_b128 v[104:107], v19 offset:36864
    v_mfma_f32_16x16x32_bf16 v[156:159], v[124:127], v[80:83], v[156:159]
    ds_read_b128 v[108:111], v19 offset:37888
    buffer_load_dwordx4 v[64:67], v20, s[4:7], s81 offen offset:3072 sc1
    buffer_load_dwordx4 v[68:71], v20, s[4:7], s82 offen offset:3072 sc1
    s_add_u32 s81, s81, 4096
    s_add_u32 s82, s82, 4096
    v_mfma_f32_16x16x32_bf16 v[160:163], v[128:131], v[80:83], v[160:163]
    ds_read_b128 v[112:115], v19 offset:38912
    v_mfma_f32_16x16x32_bf16 v[164:167], v[132:135], v[80:83], v[164:167]
    ds_read_b128 v[116:119], v19 offset:39936
    s_waitcnt vmcnt(14) lgkmcnt(4)
    v_mfma_f32_16x16x32_bf16 v[152:155], v[136:139], v[88:91], v[152:155]
    ds_read_b128 v[120:123], v18 offset:40960
    v_mfma_f32_16x16x32_bf16 v[156:159], v[140:143], v[88:91], v[156:159]
    ds_read_b128 v[124:127], v18 offset:41984
    buffer_load_dwordx4 v[72:75], v20, s[4:7], s81 offen offset:0 sc1
    buffer_load_dwordx4 v[76:79], v20, s[4:7], s82 offen offset:0 sc1
    v_mfma_f32_16x16x32_bf16 v[160:163], v[144:147], v[88:91], v[160:163]
    ds_read_b128 v[128:131], v18 offset:43008
    v_mfma_f32_16x16x32_bf16 v[164:167], v[148:151], v[88:91], v[164:167]
    ds_read_b128 v[132:135], v18 offset:44032
    s_waitcnt vmcnt(14) lgkmcnt(4)
    v_mfma_f32_16x16x32_bf16 v[152:155], v[104:107], v[96:99], v[152:155]
    ds_read_b128 v[136:139], v19 offset:45056
    v_mfma_f32_16x16x32_bf16 v[156:159], v[108:111], v[96:99], v[156:159]
    ds_read_b128 v[140:143], v19 offset:46080
    buffer_load_dwordx4 v[80:83], v20, s[4:7], s81 offen offset:1024 sc1
    buffer_load_dwordx4 v[84:87], v20, s[4:7], s82 offen offset:1024 sc1
    v_mfma_f32_16x16x32_bf16 v[160:163], v[112:115], v[96:99], v[160:163]
    ds_read_b128 v[144:147], v19 offset:47104
    v_mfma_f32_16x16x32_bf16 v[164:167], v[116:119], v[96:99], v[164:167]
    ds_read_b128 v[148:151], v19 offset:48128
    s_waitcnt vmcnt(14) lgkmcnt(4)
    v_mfma_f32_16x16x32_bf16 v[152:155], v[120:123], v[24:27], v[152:155]
    ds_read_b128 v[104:107], v18 offset:49152
    v_mfma_f32_16x16x32_bf16 v[156:159], v[124:127], v[24:27], v[156:159]
    ds_read_b128 v[108:111], v18 offset:50176
    buffer_load_dwordx4 v[88:91], v20, s[4:7], s81 offen offset:2048 sc1
    buffer_load_dwordx4 v[92:95], v20, s[4:7], s82 offen offset:2048 sc1
    v_mfma_f32_16x16x32_bf16 v[160:163], v[128:131], v[24:27], v[160:163]
    ds_read_b128 v[112:115], v18 offset:51200
    v_mfma_f32_16x16x32_bf16 v[164:167], v[132:135], v[24:27], v[164:167]
    ds_read_b128 v[116:119], v18 offset:52224
    s_waitcnt vmcnt(14) lgkmcnt(4)
    v_mfma_f32_16x16x32_bf16 v[152:155], v[136:139], v[32:35], v[152:155]
    ds_read_b128 v[120:123], v19 offset:53248
    v_mfma_f32_16x16x32_bf16 v[156:159], v[140:143], v[32:35], v[156:159]
    ds_read_b128 v[124:127], v19 offset:54272
    buffer_load_dwordx4 v[96:99], v20, s[4:7], s81 offen offset:3072 sc1
    buffer_load_dwordx4 v[100:103], v20, s[4:7], s82 offen offset:3072 sc1
    v_mfma_f32_16x16x32_bf16 v[160:163], v[144:147], v[32:35], v[160:163]
    ds_read_b128 v[128:131], v19 offset:55296
    v_mfma_f32_16x16x32_bf16 v[164:167], v[148:151], v[32:35], v[164:167]
    ds_read_b128 v[132:135], v19 offset:56320
    s_waitcnt vmcnt(14) lgkmcnt(4)
    v_mfma_f32_16x16x32_bf16 v[152:155], v[104:107], v[40:43], v[152:155]
    ds_read_b128 v[136:139], v18 offset:57344
    v_mfma_f32_16x16x32_bf16 v[156:159], v[108:111], v[40:43], v[156:159]
    ds_read_b128 v[140:143], v18 offset:58368
    v_mfma_f32_16x16x32_bf16 v[160:163], v[112:115], v[40:43], v[160:163]
    ds_read_b128 v[144:147], v18 offset:59392
    v_mfma_f32_16x16x32_bf16 v[164:167], v[116:119], v[40:43], v[164:167]
    ds_read_b128 v[148:151], v18 offset:60416
    s_waitcnt vmcnt(12) lgkmcnt(4)
    v_mfma_f32_16x16x32_bf16 v[152:155], v[120:123], v[48:51], v[152:155]
    ds_read_b128 v[104:107], v19 offset:61440
    v_mfma_f32_16x16x32_bf16 v[156:159], v[124:127], v[48:51], v[156:159]
    ds_read_b128 v[108:111], v19 offset:62464
    v_mfma_f32_16x16x32_bf16 v[160:163], v[128:131], v[48:51], v[160:163]
    ds_read_b128 v[112:115], v19 offset:63488
    v_mfma_f32_16x16x32_bf16 v[164:167], v[132:135], v[48:51], v[164:167]
    ds_read_b128 v[116:119], v19 offset:64512
    s_waitcnt vmcnt(10) lgkmcnt(4)
    v_add_u32 v18, 65536, v18
    v_mfma_f32_16x16x32_bf16 v[152:155], v[136:139], v[56:59], v[152:155]
    ds_read_b128 v[120:123], v18 offset:0
    v_mfma_f32_16x16x32_bf16 v[156:159], v[140:143], v[56:59], v[156:159]
    ds_read_b128 v[124:127], v18 offset:1024
    v_mfma_f32_16x16x32_bf16 v[160:163], v[144:147], v[56:59], v[160:163]
    ds_read_b128 v[128:131], v18 offset:2048
    v_mfma_f32_16x16x32_bf16 v[164:167], v[148:151], v[56:59], v[164:167]
    ds_read_b128 v[132:135], v18 offset:3072
    s_waitcnt vmcnt(8) lgkmcnt(4)
    v_add_u32 v19, 65536, v19
    v_mfma_f32_16x16x32_bf16 v[152:155], v[104:107], v[64:67], v[152:155]
    ds_read_b128 v[136:139], v19 offset:4096
    v_mfma_f32_16x16x32_bf16 v[156:159], v[108:111], v[64:67], v[156:159]
    ds_read_b128 v[140:143], v19 offset:5120
    v_mfma_f32_16x16x32_bf16 v[160:163], v[112:115], v[64:67], v[160:163]
    ds_read_b128 v[144:147], v19 offset:6144
    v_mfma_f32_16x16x32_bf16 v[164:167], v[116:119], v[64:67], v[164:167]
    ds_read_b128 v[148:151], v19 offset:7168
    s_waitcnt vmcnt(6) lgkmcnt(4)
    v_mfma_f32_16x16x32_bf16 v[152:155], v[120:123], v[72:75], v[152:155]
    ds_read_b128 v[104:107], v18 offset:8192
    v_mfma_f32_16x16x32_bf16 v[156:159], v[124:127], v[72:75], v[156:159]
    ds_read_b128 v[108:111], v18 offset:9216
    v_mfma_f32_16x16x32_bf16 v[160:163], v[128:131], v[72:75], v[160:163]
    ds_read_b128 v[112:115], v18 offset:10240
    v_mfma_f32_16x16x32_bf16 v[164:167], v[132:135], v[72:75], v[164:167]
    ds_read_b128 v[116:119], v18 offset:11264
    s_waitcnt vmcnt(4) lgkmcnt(4)
    v_mfma_f32_16x16x32_bf16 v[152:155], v[136:139], v[80:83], v[152:155]
    ds_read_b128 v[120:123], v19 offset:12288
    v_mfma_f32_16x16x32_bf16 v[156:159], v[140:143], v[80:83], v[156:159]
    ds_read_b128 v[124:127], v19 offset:13312
    v_mfma_f32_16x16x32_bf16 v[160:163], v[144:147], v[80:83], v[160:163]
    ds_read_b128 v[128:131], v19 offset:14336
    v_mfma_f32_16x16x32_bf16 v[164:167], v[148:151], v[80:83], v[164:167]
    ds_read_b128 v[132:135], v19 offset:15360
    s_waitcnt vmcnt(2) lgkmcnt(4)
    v_mfma_f32_16x16x32_bf16 v[152:155], v[104:107], v[88:91], v[152:155]
    v_mfma_f32_16x16x32_bf16 v[156:159], v[108:111], v[88:91], v[156:159]
    v_mfma_f32_16x16x32_bf16 v[160:163], v[112:115], v[88:91], v[160:163]
    v_mfma_f32_16x16x32_bf16 v[164:167], v[116:119], v[88:91], v[164:167]
    s_waitcnt vmcnt(0) lgkmcnt(0)
    v_mfma_f32_16x16x32_bf16 v[152:155], v[120:123], v[96:99], v[152:155]
    v_mfma_f32_16x16x32_bf16 v[156:159], v[124:127], v[96:99], v[156:159]
    v_mfma_f32_16x16x32_bf16 v[160:163], v[128:131], v[96:99], v[160:163]
    v_mfma_f32_16x16x32_bf16 v[164:167], v[132:135], v[96:99], v[164:167]
    s_nop 6
    s_lshl_b32 s78, s77, 6
    s_lshl_b32 s79, s76, 1
    s_add_u32 s78, s78, s79
    s_mul_i32 s78, s78, 10496
    s_add_u32 s78, s78, 4002816
    s_sub_u32 s79, s10, 5
    s_lshl_b32 s79, s79, 9
    s_add_u32 s78, s78, s79
    s_add_u32 s88, s78, 10496
    v_mul_u32_u24 v15, 1280, v185
    v_lshl_add_u32 v15, v184, 4, v15
    v_cvt_pk_bf16_f32 v104, v152, v153
    v_cvt_pk_bf16_f32 v105, v154, v155
    v_cvt_pk_bf16_f32 v106, v156, v157
    v_cvt_pk_bf16_f32 v107, v158, v159
    buffer_store_dwordx4 v[104:107], v15, s[4:7], s78 offen offset:0 sc1
    v_cvt_pk_bf16_f32 v108, v160, v161
    v_cvt_pk_bf16_f32 v109, v162, v163
    v_cvt_pk_bf16_f32 v110, v164, v165
    v_cvt_pk_bf16_f32 v111, v166, v167
    buffer_store_dwordx4 v[108:111], v15, s[4:7], s88 offen offset:0 sc1
L_qkv_fin_234039:
    v_mov_b32 v2, 135168
    v_mov_b32 v4, 0
    v_mov_b32 v5, 0
    ds_write_b64 v2, v[4:5]
    s_waitcnt vmcnt(0) lgkmcnt(0)
    s_barrier
    s_cmp_ge_u32 s10, 4
    s_cbranch_scc1 L_helpers_234001
    v_mov_b32 v6, 0x40000
    v_mov_b32 v7, 1
    s_cmp_eq_u32 s10, 0
    s_cselect_b32 s22, 135168, 0
    s_cselect_b32 s23, 0, 1
    s_lshl_b32 s23, s23, 18
    s_or_b32 s22, s22, s23
    v_writelane_b32 v6, s22, 0
    s_and_b32 s54, s2, 7
    s_lshl_b32 s54, s54, 2
    s_lshr_b32 s60, s2, 3
    s_and_b32 s61, s60, 3
    s_add_u32 s54, s54, s61
    s_lshr_b32 s55, s60, 2
    s_lshr_b32 s63, s10, 1
    s_and_b32 s64, s10, 1
    s_lshr_b32 s57, s54, 2
    s_mul_i32 s57, s57, 671744
    s_add_u32 s57, s57, 3997696
    s_mul_i32 s60, s63, 335872
    s_add_u32 s56, s57, s60
    s_lshl_b32 s60, s54, 6
    s_lshl_b32 s61, s55, 3
    s_add_u32 s60, s60, s61
    s_lshl_b32 s61, s64, 2
    s_add_u32 s60, s60, s61
    s_lshl_b32 s61, s63, 1
    s_add_u32 s62, s60, s61
    s_xor_b32 s59, s62, 2
    s_mul_i32 s62, s62, 1280
    s_add_u32 s62, s62, 1376256
    s_mul_i32 s59, s59, 1280
    s_add_u32 s59, s59, 1376256
    s_mov_b32 s70, 0
    s_mov_b32 s71, -1
    v_lshlrev_b32 v8, 4, v1
    v_and_b32 v13, 31, v1
    v_lshrrev_b32 v14, 5, v1
    v_lshlrev_b32 v15, 3, v13
    v_lshl_add_u32 v12, v14, 30, v15
    s_lshl_b32 s60, s55, 3
    s_lshl_b32 s61, s64, 2
    s_add_u32 s60, s60, s61
    s_lshl_b32 s61, s63, 1
    s_add_u32 s60, s60, s61
    s_mul_i32 s60, s60, 40960
    s_add_u32 s60, s60, 9371648
    s_lshr_b32 s61, s54, 1
    s_lshl_b32 s65, s61, 10
    s_and_b32 s67, s54, 1
    s_lshl_b32 s68, s67, 9
    s_add_u32 s65, s65, s68
    s_add_u32 s65, s65, s60
    s_lshl_b32 s61, s54, 7
    s_add_u32 s61, s61, 16384
    s_add_u32 s66, s61, s60
    s_mul_i32 s60, s10, 6144
    s_add_u32 s60, s60, 106496
    s_xor_b32 s61, s10, 2
    s_mul_i32 s61, s61, 6144
    s_add_u32 s61, s61, 106496
    v_add_u32 v18, s60, v8
    v_add_u32 v19, s61, v8
    v_bfe_u32 v10, v1, 4, 1
    v_mul_u32_u24 v10, 20480, v10
    v_and_b32 v11, 15, v1
    v_lshl_add_u32 v16, v11, 4, v10
    v_lshl_add_u32 v17, v11, 3, v10
    v_lshrrev_b32 v10, 5, v1
    v_lshl_add_u32 v16, v10, 8, v16
    v_lshl_add_u32 v17, v10, 30, v17
    v_mov_b32 v104, v12
    s_and_b32 s60, s54, 3
    s_lshl_b32 s61, s60, 10
    v_add_u32 v20, s61, v8
    s_lshl_b32 s61, s60, 8
    s_add_u32 s61, s61, 4096
    v_add_u32 v15, s61, v15
    s_mul_i32 s60, s60, 320
    s_add_u32 s60, s60, 5120
    v_mov_b32 v9, 10240
    v_cmp_gt_u32 vcc, 32, v1
    v_mul_u32_u24 v10, 80, v14
    v_add_u32 v10, v10, v13
    v_cndmask_b32 v9, v9, v15, vcc
    v_lshlrev_b32 v10, 4, v10
    v_add_u32 v10, s60, v10
    v_add_u32 v11, 2560, v10
    v_mov_b32 v15, 10240
    v_mov_b32 v14, 10368
    v_cmp_eq_u32 vcc, 20, v13
    v_mov_b32 v12, 0xdddd
    s_nop 0
    v_cndmask_b32 v15, v14, v15, vcc
    v_cmp_gt_u32 vcc, 20, v13
    s_nop 1
    v_cndmask_b32 v10, v15, v10, vcc
    v_cndmask_b32 v11, v15, v11, vcc
    v_mov_b32 v128, 0
    v_mov_b32 v129, 0
    v_mov_b32 v130, 0
    v_mov_b32 v131, 0
    v_mov_b32 v132, 0
    v_mov_b32 v133, 0
    v_mov_b32 v134, 0
    v_mov_b32 v135, 0
    v_mov_b32 v98, 0
    v_mov_b32 v99, 0
    v_mov_b32 v100, 0
    v_mov_b32 v101, 0
    v_mov_b32 v136, 0
    v_mov_b32 v137, 0
    v_mov_b32 v138, 0
    v_mov_b32 v139, 0
    v_mov_b32 v140, 0
    v_mov_b32 v141, 0
    v_mov_b32 v142, 0
    v_mov_b32 v143, 0
    v_mov_b32 v144, 0
    v_mov_b32 v145, 0
    v_mov_b32 v146, 0
    v_mov_b32 v147, 0
    v_mov_b32 v148, 0
    v_mov_b32 v149, 0
    v_mov_b32 v150, 0
    v_mov_b32 v151, 0
    v_mov_b32 v152, 0
    v_mov_b32 v153, 0
    v_mov_b32 v154, 0
    v_mov_b32 v155, 0
    v_mov_b32 v156, 0
    v_mov_b32 v157, 0
    v_mov_b32 v158, 0
    v_mov_b32 v159, 0
    v_mov_b32 v160, 0
    v_mov_b32 v161, 0
    v_mov_b32 v162, 0
    v_mov_b32 v163, 0
    v_mov_b32 v164, 0
    v_mov_b32 v165, 0
    v_mov_b32 v166, 0
    v_mov_b32 v167, 0
    s_cmp_lg_u32 s10, 0
    s_cbranch_scc1 L_m_nw0_234002
    s_bfe_u32 s23, s2, 0x20001
    s_lshl_b32 s23, s23, 3
    s_lshr_b32 s24, s2, 5
    s_add_u32 s23, s23, s24
    s_and_b32 s22, s2, 1
    s_lshl_b32 s22, s22, 2
    s_bfe_u32 s24, s2, 0x20003
    s_add_u32 s22, s22, s24
    s_and_b32 s24, s22, 7
    s_mul_i32 s24, s24, 2048
    s_mul_i32 s22, s22, 16384
    s_add_u32 s22, s22, s24
    s_and_b32 s24, s23, 3
    s_lshl_b32 s24, s24, 8
    s_add_u32 s22, s22, s24
    s_add_u32 s22, s22, 131072
    s_mov_b64 exec, 1
    v_mul_u32_u24 v2, 2048, v1
    v_mov_b32 v3, 1
    buffer_atomic_add v3, v2, s[4:7], s22 offen sc1
    s_mov_b64 exec, -1
    s_and_b32 s22, s2, 7
    s_mul_i32 s22, s22, 16384
    s_bfe_u32 s23, s2, 196608
    s_mul_i32 s23, s23, 2048
    s_add_u32 s22, s22, s23
    s_add_u32 s22, s22, 131072
    s_mov_b64 exec, 15
    v_lshlrev_b32 v2, 8, v1
    v_mov_b32 v3, 8
    s_mov_b32 s23, 1048576
L_poll_234042:
    buffer_load_dword v4, v2, s[4:7], s22 offen sc1
    s_sub_u32 s23, s23, 1
    s_cbranch_scc1 L_poll_out_234043
    s_waitcnt vmcnt(0)
    v_cmp_gt_u32 vcc, v3, v4
    s_nop 0
    s_cbranch_vccz L_poll_out_234043
    s_sleep 0
    s_branch L_poll_234042
L_poll_out_234043:
    s_waitcnt vmcnt(0)
    s_mov_b64 exec, -1
    v_mov_b32 v2, 135168
    v_mov_b32 v3, 1
    ds_write_b32 v2, v3
    s_branch L_m_go_234003
L_m_nw0_234002:
    v_mov_b32 v2, 135168
    s_mov_b32 s23, 8388608
L_m_spin_234044:
    ds_read_b32 v3, v2
    s_sub_u32 s23, s23, 1
    s_cbranch_scc1 L_m_spin_out_234045
    s_waitcnt lgkmcnt(0)
    v_cmp_gt_u32 vcc, 1, v3
    s_sleep 1
    s_cbranch_vccnz L_m_spin_234044
L_m_spin_out_234045:
    s_waitcnt lgkmcnt(0)
L_m_go_234003:
    s_waitcnt lgkmcnt(0)
    s_add_u32 s72, s4, s57
    s_addc_u32 s73, s5, 0
    global_load_dwordx4 v[58:61], v20, s[72:73] sc1
    global_load_dwordx2 v[68:69], v9, s[72:73] sc1
    s_add_u32 s72, s4, s56
    s_addc_u32 s73, s5, 0
    buffer_load_dwordx4 v[22:25], v8, s[4:7], s62 offen offset:0 sc1
    buffer_load_dwordx2 v[38:39], v104, s[4:7], s62 offen offset:1024 sc1
    buffer_load_dwordx4 v[26:29], v8, s[4:7], s62 offen offset:1280 sc1
    buffer_load_dwordx2 v[40:41], v104, s[4:7], s62 offen offset:2304 sc1
    buffer_load_dwordx4 v[30:33], v8, s[4:7], s59 offen offset:0 sc1
    buffer_load_dwordx2 v[42:43], v104, s[4:7], s59 offen offset:1024 sc1
    buffer_load_dwordx4 v[34:37], v8, s[4:7], s59 offen offset:1280 sc1
    buffer_load_dwordx2 v[44:45], v104, s[4:7], s59 offen offset:2304 sc1
    s_mov_b32 s59, 0
    global_load_dwordx4 v[46:49], v20, s[72:73] sc1
    global_load_dwordx4 v[86:89], v11, s[72:73] sc1
    global_load_dwordx2 v[62:63], v9, s[72:73] sc1
    global_load_dwordx4 v[70:73], v10, s[72:73] sc1
    s_add_u32 s72, s72, 10496
    s_addc_u32 s73, s73, 0
    global_load_dwordx4 v[50:53], v20, s[72:73] sc1
    global_load_dwordx4 v[90:93], v11, s[72:73] sc1
    global_load_dwordx2 v[64:65], v9, s[72:73] sc1
    global_load_dwordx4 v[74:77], v10, s[72:73] sc1
    s_add_u32 s72, s72, 10496
    s_addc_u32 s73, s73, 0
    s_waitcnt vmcnt(8)
    v_mfma_f32_32x32x16_bf16 v[104:119], v[58:61], v[22:25], 0
    v_mfma_f32_32x32x8bf16_1k v[104:119], v[68:69], v[38:39], v[104:119]
    v_mfma_f32_32x32x16_bf16 v[120:135], v[58:61], v[26:29], 0
    v_mfma_f32_32x32x8bf16_1k v[120:135], v[68:69], v[40:41], v[120:135]
    v_mfma_f32_32x32x16_bf16 v[168:183], v[58:61], v[30:33], 0
    v_mfma_f32_32x32x8bf16_1k v[168:183], v[68:69], v[42:43], v[168:183]
    v_mfma_f32_32x32x16_bf16 v[184:199], v[58:61], v[34:37], 0
    v_mfma_f32_32x32x8bf16_1k v[184:199], v[68:69], v[44:45], v[184:199]
    global_load_dwordx4 v[54:57], v20, s[72:73] sc1
    global_load_dwordx4 v[94:97], v11, s[72:73] sc1
    global_load_dwordx2 v[66:67], v9, s[72:73] sc1
    global_load_dwordx4 v[78:81], v10, s[72:73] sc1
    s_add_u32 s72, s72, 10496
    s_addc_u32 s73, s73, 0
    v_max3_f32 v13, v104, v105, v106
    v_max_f32 v13, v13, v107
    v_max3_f32 v13, v13, v108, v109
    v_max3_f32 v13, v13, v110, v111
    v_max3_f32 v13, v13, v112, v113
    v_max3_f32 v13, v13, v114, v115
    v_max3_f32 v13, v13, v116, v117
    v_max3_f32 v13, v13, v118, v119
    v_mov_b32 v14, v13
    s_nop 1
    v_permlane32_swap_b32 v13, v14
    v_max_f32 v13, v13, v14
    v_sub_f32 v13, 0xc2200000, v13
    v_cvt_pk_bf16_f32 v13, v13, 0
    s_mov_b64 exec, s[70:71]
    v_mov_b32 v38, v13
    s_mov_b64 exec, -1
    v_max3_f32 v13, v120, v121, v122
    v_max_f32 v13, v13, v123
    v_max3_f32 v13, v13, v124, v125
    v_max3_f32 v13, v13, v126, v127
    v_max3_f32 v13, v13, v128, v129
    v_max3_f32 v13, v13, v130, v131
    v_max3_f32 v13, v13, v132, v133
    v_max3_f32 v13, v13, v134, v135
    v_mov_b32 v14, v13
    v_mov_b32 v128, 0
    v_mov_b32 v129, 0
    v_permlane32_swap_b32 v13, v14
    v_mov_b32 v130, 0
    v_mov_b32 v131, 0
    v_mov_b32 v132, 0
    v_mov_b32 v133, 0
    v_mov_b32 v134, 0
    v_mov_b32 v135, 0
    v_max_f32 v13, v13, v14
    v_sub_f32 v13, 0xc2200000, v13
    v_cvt_pk_bf16_f32 v13, v13, 0
    s_mov_b64 exec, s[70:71]
    v_mov_b32 v40, v13
    s_mov_b64 exec, -1
    v_max3_f32 v13, v168, v169, v170
    v_max_f32 v13, v13, v171
    v_max3_f32 v13, v13, v172, v173
    v_max3_f32 v13, v13, v174, v175
    v_max3_f32 v13, v13, v176, v177
    v_max3_f32 v13, v13, v178, v179
    v_max3_f32 v13, v13, v180, v181
    v_max3_f32 v13, v13, v182, v183
    v_mov_b32 v14, v13
    v_mov_b32 v168, 0
    v_mov_b32 v169, 0
    v_permlane32_swap_b32 v13, v14
    v_mov_b32 v170, 0
    v_mov_b32 v171, 0
    v_mov_b32 v172, 0
    v_mov_b32 v173, 0
    v_mov_b32 v174, 0
    v_mov_b32 v175, 0
    v_mov_b32 v176, 0
    v_mov_b32 v177, 0
    v_mov_b32 v178, 0
    v_mov_b32 v179, 0
    v_mov_b32 v180, 0
    v_mov_b32 v181, 0
    v_mov_b32 v182, 0
    v_mov_b32 v183, 0
    v_max_f32 v13, v13, v14
    v_sub_f32 v13, 0xc2200000, v13
    v_cvt_pk_bf16_f32 v13, v13, 0
    s_mov_b64 exec, s[70:71]
    v_mov_b32 v42, v13
    s_mov_b64 exec, -1
    s_nop 3
    v_max3_f32 v13, v184, v185, v186
    v_max_f32 v13, v13, v187
    v_max3_f32 v13, v13, v188, v189
    v_max3_f32 v13, v13, v190, v191
    v_max3_f32 v13, v13, v192, v193
    v_max3_f32 v13, v13, v194, v195
    v_max3_f32 v13, v13, v196, v197
    v_max3_f32 v13, v13, v198, v199
    v_mov_b32 v14, v13
    v_mov_b32 v184, 0
    v_mov_b32 v185, 0
    v_permlane32_swap_b32 v13, v14
    v_mov_b32 v186, 0
    v_mov_b32 v187, 0
    v_mov_b32 v188, 0
    v_mov_b32 v189, 0
    v_mov_b32 v190, 0
    v_mov_b32 v191, 0
    v_mov_b32 v192, 0
    v_mov_b32 v193, 0
    v_mov_b32 v194, 0
    v_mov_b32 v195, 0
    v_mov_b32 v196, 0
    v_mov_b32 v197, 0
    v_mov_b32 v198, 0
    v_mov_b32 v199, 0
    v_max_f32 v13, v13, v14
    v_sub_f32 v13, 0xc2200000, v13
    v_cvt_pk_bf16_f32 v13, v13, 0
    s_mov_b64 exec, s[70:71]
    v_mov_b32 v44, v13
    s_mov_b64 exec, -1
    s_waitcnt vmcnt(8)
    v_mfma_f32_32x32x16_bf16 v[104:119], v[46:49], v[22:25], 0
    v_mfma_f32_32x32x8bf16_1k v[104:119], v[62:63], v[38:39], v[104:119]
    s_nop 10
    .p2align 6
L_attn_loop_234046:
    v_exp_f32 v104, v104
    v_exp_f32 v105, v105
    v_smfmac_f32_32x32x32_bf16 v[184:199], v[98:101], v[128:135], v12
    s_cmp_eq_u32 s59, 7
    s_cselect_b32 s74, 0, 10496
    v_exp_f32 v106, v106
    v_exp_f32 v107, v107
    v_exp_f32 v108, v108
    v_exp_f32 v109, v109
    v_mfma_f32_32x32x16_bf16 v[120:135], v[46:49], v[26:29], 0
    v_exp_f32 v110, v110
    v_exp_f32 v111, v111
    v_exp_f32 v112, v112
    v_exp_f32 v113, v113
    v_mfma_f32_32x32x8bf16_1k v[120:135], v[62:63], v[40:41], v[120:135]
    v_exp_f32 v114, v114
    v_exp_f32 v115, v115
    v_exp_f32 v116, v116
    v_exp_f32 v117, v117
    v_smfmac_f32_32x32x32_bf16 v[136:151], v[70:73], v[104:111], v12
    v_exp_f32 v118, v118
    v_exp_f32 v119, v119
    v_exp_f32 v120, v120
    v_exp_f32 v121, v121
    v_smfmac_f32_32x32x32_bf16 v[136:151], v[86:89], v[112:119], v12
    global_load_dwordx4 v[58:61], v20, s[72:73] sc1
    global_load_dwordx4 v[98:101], v11, s[72:73] sc1
    global_load_dwordx2 v[68:69], v9, s[72:73] sc1
    global_load_dwordx4 v[82:85], v10, s[72:73] sc1
    ds_add_u32 v6, v7
    v_exp_f32 v122, v122
    v_exp_f32 v123, v123
    v_exp_f32 v124, v124
    v_exp_f32 v125, v125
    v_mfma_f32_32x32x16_bf16 v[104:119], v[46:49], v[30:33], 0
    v_exp_f32 v126, v126
    v_exp_f32 v127, v127
    v_exp_f32 v128, v128
    v_exp_f32 v129, v129
    v_mfma_f32_32x32x8bf16_1k v[104:119], v[62:63], v[42:43], v[104:119]
    v_exp_f32 v130, v130
    v_exp_f32 v131, v131
    v_exp_f32 v132, v132
    v_exp_f32 v133, v133
    v_smfmac_f32_32x32x32_bf16 v[152:167], v[70:73], v[120:127], v12
    v_exp_f32 v134, v134
    v_exp_f32 v135, v135
    v_exp_f32 v104, v104
    v_exp_f32 v105, v105
    v_smfmac_f32_32x32x32_bf16 v[152:167], v[86:89], v[128:135], v12
    s_add_u32 s72, s72, s74
    s_addc_u32 s73, s73, 0
    v_exp_f32 v106, v106
    v_exp_f32 v107, v107
    v_exp_f32 v108, v108
    v_exp_f32 v109, v109
    v_mfma_f32_32x32x16_bf16 v[120:135], v[46:49], v[34:37], 0
    v_exp_f32 v110, v110
    v_exp_f32 v111, v111
    v_exp_f32 v112, v112
    v_exp_f32 v113, v113
    v_mfma_f32_32x32x8bf16_1k v[120:135], v[62:63], v[44:45], v[120:135]
    v_exp_f32 v114, v114
    v_exp_f32 v115, v115
    v_exp_f32 v116, v116
    v_exp_f32 v117, v117
    v_smfmac_f32_32x32x32_bf16 v[168:183], v[70:73], v[104:111], v12
    v_exp_f32 v118, v118
    v_exp_f32 v119, v119
    v_exp_f32 v120, v120
    v_exp_f32 v121, v121
    v_smfmac_f32_32x32x32_bf16 v[168:183], v[86:89], v[112:119], v12
    s_waitcnt vmcnt(8)
    v_exp_f32 v122, v122
    v_exp_f32 v123, v123
    v_exp_f32 v124, v124
    v_exp_f32 v125, v125
    v_mfma_f32_32x32x16_bf16 v[104:119], v[50:53], v[22:25], 0
    v_exp_f32 v126, v126
    v_exp_f32 v127, v127
    v_exp_f32 v128, v128
    v_exp_f32 v129, v129
    v_mfma_f32_32x32x8bf16_1k v[104:119], v[64:65], v[38:39], v[104:119]
    v_exp_f32 v130, v130
    v_exp_f32 v131, v131
    v_exp_f32 v132, v132
    v_exp_f32 v133, v133
    v_smfmac_f32_32x32x32_bf16 v[184:199], v[70:73], v[120:127], v12
    v_exp_f32 v134, v134
    v_exp_f32 v135, v135
    v_exp_f32 v104, v104
    v_exp_f32 v105, v105
    v_smfmac_f32_32x32x32_bf16 v[184:199], v[86:89], v[128:135], v12
    v_exp_f32 v106, v106
    v_exp_f32 v107, v107
    v_exp_f32 v108, v108
    v_exp_f32 v109, v109
    v_mfma_f32_32x32x16_bf16 v[120:135], v[50:53], v[26:29], 0
    v_exp_f32 v110, v110
    v_exp_f32 v111, v111
    v_exp_f32 v112, v112
    v_exp_f32 v113, v113
    v_mfma_f32_32x32x8bf16_1k v[120:135], v[64:65], v[40:41], v[120:135]
    v_exp_f32 v114, v114
    v_exp_f32 v115, v115
    v_exp_f32 v116, v116
    v_exp_f32 v117, v117
    v_smfmac_f32_32x32x32_bf16 v[136:151], v[74:77], v[104:111], v12
    v_exp_f32 v118, v118
    v_exp_f32 v119, v119
    v_exp_f32 v120, v120
    v_exp_f32 v121, v121
    v_smfmac_f32_32x32x32_bf16 v[136:151], v[90:93], v[112:119], v12
    global_load_dwordx4 v[46:49], v20, s[72:73] sc1
    global_load_dwordx4 v[86:89], v11, s[72:73] sc1
    global_load_dwordx2 v[62:63], v9, s[72:73] sc1
    global_load_dwordx4 v[70:73], v10, s[72:73] sc1
    ds_add_u32 v6, v7
    v_exp_f32 v122, v122
    v_exp_f32 v123, v123
    v_exp_f32 v124, v124
    v_exp_f32 v125, v125
    v_mfma_f32_32x32x16_bf16 v[104:119], v[50:53], v[30:33], 0
    v_exp_f32 v126, v126
    v_exp_f32 v127, v127
    v_exp_f32 v128, v128
    v_exp_f32 v129, v129
    v_mfma_f32_32x32x8bf16_1k v[104:119], v[64:65], v[42:43], v[104:119]
    v_exp_f32 v130, v130
    v_exp_f32 v131, v131
    v_exp_f32 v132, v132
    v_exp_f32 v133, v133
    v_smfmac_f32_32x32x32_bf16 v[152:167], v[74:77], v[120:127], v12
    v_exp_f32 v134, v134
    v_exp_f32 v135, v135
    v_exp_f32 v104, v104
    v_exp_f32 v105, v105
    v_smfmac_f32_32x32x32_bf16 v[152:167], v[90:93], v[128:135], v12
    s_add_u32 s72, s72, s74
    s_addc_u32 s73, s73, 0
    v_exp_f32 v106, v106
    v_exp_f32 v107, v107
    v_exp_f32 v108, v108
    v_exp_f32 v109, v109
    v_mfma_f32_32x32x16_bf16 v[120:135], v[50:53], v[34:37], 0
    v_exp_f32 v110, v110
    v_exp_f32 v111, v111
    v_exp_f32 v112, v112
    v_exp_f32 v113, v113
    v_mfma_f32_32x32x8bf16_1k v[120:135], v[64:65], v[44:45], v[120:135]
    v_exp_f32 v114, v114
    v_exp_f32 v115, v115
    v_exp_f32 v116, v116
    v_exp_f32 v117, v117
    v_smfmac_f32_32x32x32_bf16 v[168:183], v[74:77], v[104:111], v12
    v_exp_f32 v118, v118
    v_exp_f32 v119, v119
    v_exp_f32 v120, v120
    v_exp_f32 v121, v121
    v_smfmac_f32_32x32x32_bf16 v[168:183], v[90:93], v[112:119], v12
    s_waitcnt vmcnt(8)
    v_exp_f32 v122, v122
    v_exp_f32 v123, v123
    v_exp_f32 v124, v124
    v_exp_f32 v125, v125
    v_mfma_f32_32x32x16_bf16 v[104:119], v[54:57], v[22:25], 0
    v_exp_f32 v126, v126
    v_exp_f32 v127, v127
    v_exp_f32 v128, v128
    v_exp_f32 v129, v129
    v_mfma_f32_32x32x8bf16_1k v[104:119], v[66:67], v[38:39], v[104:119]
    v_exp_f32 v130, v130
    v_exp_f32 v131, v131
    v_exp_f32 v132, v132
    v_exp_f32 v133, v133
    v_smfmac_f32_32x32x32_bf16 v[184:199], v[74:77], v[120:127], v12
    v_exp_f32 v134, v134
    v_exp_f32 v135, v135
    v_exp_f32 v104, v104
    v_exp_f32 v105, v105
    v_smfmac_f32_32x32x32_bf16 v[184:199], v[90:93], v[128:135], v12
    v_exp_f32 v106, v106
    v_exp_f32 v107, v107
    v_exp_f32 v108, v108
    v_exp_f32 v109, v109
    v_mfma_f32_32x32x16_bf16 v[120:135], v[54:57], v[26:29], 0
    v_exp_f32 v110, v110
    v_exp_f32 v111, v111
    v_exp_f32 v112, v112
    v_exp_f32 v113, v113
    v_mfma_f32_32x32x8bf16_1k v[120:135], v[66:67], v[40:41], v[120:135]
    v_exp_f32 v114, v114
    v_exp_f32 v115, v115
    v_exp_f32 v116, v116
    v_exp_f32 v117, v117
    v_smfmac_f32_32x32x32_bf16 v[136:151], v[78:81], v[104:111], v12
    v_exp_f32 v118, v118
    v_exp_f32 v119, v119
    v_exp_f32 v120, v120
    v_exp_f32 v121, v121
    v_smfmac_f32_32x32x32_bf16 v[136:151], v[94:97], v[112:119], v12
    global_load_dwordx4 v[50:53], v20, s[72:73] sc1
    global_load_dwordx4 v[90:93], v11, s[72:73] sc1
    global_load_dwordx2 v[64:65], v9, s[72:73] sc1
    global_load_dwordx4 v[74:77], v10, s[72:73] sc1
    ds_add_u32 v6, v7
    v_exp_f32 v122, v122
    v_exp_f32 v123, v123
    v_exp_f32 v124, v124
    v_exp_f32 v125, v125
    v_mfma_f32_32x32x16_bf16 v[104:119], v[54:57], v[30:33], 0
    v_exp_f32 v126, v126
    v_exp_f32 v127, v127
    v_exp_f32 v128, v128
    v_exp_f32 v129, v129
    v_mfma_f32_32x32x8bf16_1k v[104:119], v[66:67], v[42:43], v[104:119]
    v_exp_f32 v130, v130
    v_exp_f32 v131, v131
    v_exp_f32 v132, v132
    v_exp_f32 v133, v133
    v_smfmac_f32_32x32x32_bf16 v[152:167], v[78:81], v[120:127], v12
    v_exp_f32 v134, v134
    v_exp_f32 v135, v135
    v_exp_f32 v104, v104
    v_exp_f32 v105, v105
    v_smfmac_f32_32x32x32_bf16 v[152:167], v[94:97], v[128:135], v12
    s_add_u32 s72, s72, s74
    s_addc_u32 s73, s73, 0
    v_exp_f32 v106, v106
    v_exp_f32 v107, v107
    v_exp_f32 v108, v108
    v_exp_f32 v109, v109
    v_mfma_f32_32x32x16_bf16 v[120:135], v[54:57], v[34:37], 0
    v_exp_f32 v110, v110
    v_exp_f32 v111, v111
    v_exp_f32 v112, v112
    v_exp_f32 v113, v113
    v_mfma_f32_32x32x8bf16_1k v[120:135], v[66:67], v[44:45], v[120:135]
    v_exp_f32 v114, v114
    v_exp_f32 v115, v115
    v_exp_f32 v116, v116
    v_exp_f32 v117, v117
    v_smfmac_f32_32x32x32_bf16 v[168:183], v[78:81], v[104:111], v12
    v_exp_f32 v118, v118
    v_exp_f32 v119, v119
    v_exp_f32 v120, v120
    v_exp_f32 v121, v121
    v_smfmac_f32_32x32x32_bf16 v[168:183], v[94:97], v[112:119], v12
    s_waitcnt vmcnt(8)
    v_exp_f32 v122, v122
    v_exp_f32 v123, v123
    v_exp_f32 v124, v124
    v_exp_f32 v125, v125
    v_mfma_f32_32x32x16_bf16 v[104:119], v[58:61], v[22:25], 0
    v_exp_f32 v126, v126
    v_exp_f32 v127, v127
    v_exp_f32 v128, v128
    v_exp_f32 v129, v129
    v_mfma_f32_32x32x8bf16_1k v[104:119], v[68:69], v[38:39], v[104:119]
    v_exp_f32 v130, v130
    v_exp_f32 v131, v131
    v_exp_f32 v132, v132
    v_exp_f32 v133, v133
    v_smfmac_f32_32x32x32_bf16 v[184:199], v[78:81], v[120:127], v12
    v_exp_f32 v134, v134
    v_exp_f32 v135, v135
    v_exp_f32 v104, v104
    v_exp_f32 v105, v105
    v_smfmac_f32_32x32x32_bf16 v[184:199], v[94:97], v[128:135], v12
    v_exp_f32 v106, v106
    v_exp_f32 v107, v107
    v_exp_f32 v108, v108
    v_exp_f32 v109, v109
    v_mfma_f32_32x32x16_bf16 v[120:135], v[58:61], v[26:29], 0
    v_exp_f32 v110, v110
    v_exp_f32 v111, v111
    v_exp_f32 v112, v112
    v_exp_f32 v113, v113
    v_mfma_f32_32x32x8bf16_1k v[120:135], v[68:69], v[40:41], v[120:135]
    v_exp_f32 v114, v114
    v_exp_f32 v115, v115
    v_exp_f32 v116, v116
    v_exp_f32 v117, v117
    v_smfmac_f32_32x32x32_bf16 v[136:151], v[82:85], v[104:111], v12
    v_exp_f32 v118, v118
    v_exp_f32 v119, v119
    v_exp_f32 v120, v120
    v_exp_f32 v121, v121
    v_smfmac_f32_32x32x32_bf16 v[136:151], v[98:101], v[112:119], v12
    global_load_dwordx4 v[54:57], v20, s[72:73] sc1
    global_load_dwordx4 v[94:97], v11, s[72:73] sc1
    global_load_dwordx2 v[66:67], v9, s[72:73] sc1
    global_load_dwordx4 v[78:81], v10, s[72:73] sc1
    ds_add_u32 v6, v7
    v_exp_f32 v122, v122
    v_exp_f32 v123, v123
    v_exp_f32 v124, v124
    v_exp_f32 v125, v125
    v_mfma_f32_32x32x16_bf16 v[104:119], v[58:61], v[30:33], 0
    v_exp_f32 v126, v126
    v_exp_f32 v127, v127
    v_exp_f32 v128, v128
    v_exp_f32 v129, v129
    v_mfma_f32_32x32x8bf16_1k v[104:119], v[68:69], v[42:43], v[104:119]
    v_exp_f32 v130, v130
    v_exp_f32 v131, v131
    v_exp_f32 v132, v132
    v_exp_f32 v133, v133
    v_smfmac_f32_32x32x32_bf16 v[152:167], v[82:85], v[120:127], v12
    v_exp_f32 v134, v134
    v_exp_f32 v135, v135
    v_exp_f32 v104, v104
    v_exp_f32 v105, v105
    v_smfmac_f32_32x32x32_bf16 v[152:167], v[98:101], v[128:135], v12
    s_add_u32 s72, s72, s74
    s_addc_u32 s73, s73, 0
    v_exp_f32 v106, v106
    v_exp_f32 v107, v107
    v_exp_f32 v108, v108
    v_exp_f32 v109, v109
    v_mfma_f32_32x32x16_bf16 v[120:135], v[58:61], v[34:37], 0
    s_add_u32 s59, s59, 1
    v_exp_f32 v110, v110
    v_exp_f32 v111, v111
    v_exp_f32 v112, v112
    v_exp_f32 v113, v113
    v_mfma_f32_32x32x8bf16_1k v[120:135], v[68:69], v[44:45], v[120:135]
    v_exp_f32 v114, v114
    v_exp_f32 v115, v115
    v_exp_f32 v116, v116
    v_exp_f32 v117, v117
    v_smfmac_f32_32x32x32_bf16 v[168:183], v[82:85], v[104:111], v12
    v_exp_f32 v118, v118
    v_exp_f32 v119, v119
    v_exp_f32 v120, v120
    v_exp_f32 v121, v121
    v_smfmac_f32_32x32x32_bf16 v[168:183], v[98:101], v[112:119], v12
    s_waitcnt vmcnt(8)
    v_exp_f32 v122, v122
    v_exp_f32 v123, v123
    v_exp_f32 v124, v124
    v_exp_f32 v125, v125
    v_mfma_f32_32x32x16_bf16 v[104:119], v[46:49], v[22:25], 0
    s_cmp_lt_u32 s59, 8
    v_exp_f32 v126, v126
    v_exp_f32 v127, v127
    v_exp_f32 v128, v128
    v_exp_f32 v129, v129
    v_mfma_f32_32x32x8bf16_1k v[104:119], v[62:63], v[38:39], v[104:119]
    v_exp_f32 v130, v130
    v_exp_f32 v131, v131
    v_exp_f32 v132, v132
    v_exp_f32 v133, v133
    v_smfmac_f32_32x32x32_bf16 v[184:199], v[82:85], v[120:127], v12
    v_exp_f32 v134, v134
    v_exp_f32 v135, v135
    s_cbranch_scc1 L_attn_loop_234046
    s_nop 1
    v_smfmac_f32_32x32x32_bf16 v[184:199], v[98:101], v[128:135], v12
    ds_write_b128 v18, v[168:171] offset:0
    ds_write_b128 v18, v[172:175] offset:1024
    ds_write_b128 v18, v[176:179] offset:2048
    s_nop 8
    ds_write_b128 v18, v[184:187] offset:3072
    ds_write_b128 v18, v[188:191] offset:4096
    ds_write_b128 v18, v[192:195] offset:5120
    s_waitcnt lgkmcnt(0)
    s_barrier
    ds_read_b128 v[168:171], v19 offset:0
    ds_read_b128 v[172:175], v19 offset:1024
    ds_read_b128 v[176:179], v19 offset:2048
    ds_read_b128 v[184:187], v19 offset:3072
    ds_read_b128 v[188:191], v19 offset:4096
    ds_read_b128 v[192:195], v19 offset:5120
    s_waitcnt lgkmcnt(3)
    v_pk_add_f32 v[136:137], v[136:137], v[168:169]
    v_pk_add_f32 v[138:139], v[138:139], v[170:171]
    v_pk_add_f32 v[140:141], v[140:141], v[172:173]
    v_pk_add_f32 v[142:143], v[142:143], v[174:175]
    v_pk_add_f32 v[144:145], v[144:145], v[176:177]
    v_pk_add_f32 v[146:147], v[146:147], v[178:179]
    v_mov_b32 v13, v144
    v_mov_b32 v14, v144
    v_maximum3_f32 v15, abs(v136), abs(v137), abs(v138)
    s_nop 0
    v_permlane32_swap_b32 v13, v14
    v_maximum3_f32 v15, v15, abs(v139), abs(v140)
    v_maximum3_f32 v15, v15, abs(v141), abs(v142)
    v_maximum3_f32 v15, v15, abs(v143), abs(v144)
    v_maximum3_f32 v15, v15, abs(v145), abs(v146)
    v_maximum3_f32 v15, v15, abs(v147), abs(v147)
    s_mov_b32 s60, 0x7b800000
    s_mov_b32 s59, 0x7f800000
    v_cmp_nlt_f32_e64 s[8:9], v14, s60
    v_cmp_nlt_f32_e64 vcc, v15, s59
    s_or_b64 vcc, vcc, s[8:9]
    s_cbranch_vccnz L_attn_slow_234048
L_attn_fin_234047:
    v_rcp_f32 v148, v14
    s_nop 0
    v_pk_mul_f32 v[136:137], v[136:137], v[148:149] op_sel_hi:[1,0]
    v_pk_mul_f32 v[138:139], v[138:139], v[148:149] op_sel_hi:[1,0]
    v_pk_mul_f32 v[140:141], v[140:141], v[148:149] op_sel_hi:[1,0]
    v_pk_mul_f32 v[142:143], v[142:143], v[148:149] op_sel_hi:[1,0]
    v_pk_mul_f32 v[144:145], v[144:145], v[148:149] op_sel_hi:[1,0]
    v_pk_mul_f32 v[146:147], v[146:147], v[148:149] op_sel_hi:[1,0]
    v_cvt_pk_bf16_f32 v136, v136, v137
    v_cvt_pk_bf16_f32 v137, v138, v139
    v_cvt_pk_bf16_f32 v138, v140, v141
    v_cvt_pk_bf16_f32 v139, v142, v143
    v_cvt_pk_bf16_f32 v140, v144, v145
    v_cvt_pk_bf16_f32 v141, v146, v147
    buffer_store_dwordx4 v[136:139], v16, s[4:7], s65 offen sc1
    buffer_store_dwordx2 v[140:141], v17, s[4:7], s66 offen sc1
    s_add_u32 s65, s65, 40960
    s_add_u32 s66, s66, 40960
    s_waitcnt lgkmcnt(0)
    v_pk_add_f32 v[152:153], v[152:153], v[184:185]
    v_pk_add_f32 v[154:155], v[154:155], v[186:187]
    v_pk_add_f32 v[156:157], v[156:157], v[188:189]
    v_pk_add_f32 v[158:159], v[158:159], v[190:191]
    v_pk_add_f32 v[160:161], v[160:161], v[192:193]
    v_pk_add_f32 v[162:163], v[162:163], v[194:195]
    v_mov_b32 v13, v160
    v_mov_b32 v14, v160
    v_maximum3_f32 v15, abs(v152), abs(v153), abs(v154)
    s_nop 0
    v_permlane32_swap_b32 v13, v14
    v_maximum3_f32 v15, v15, abs(v155), abs(v156)
    v_maximum3_f32 v15, v15, abs(v157), abs(v158)
    v_maximum3_f32 v15, v15, abs(v159), abs(v160)
    v_maximum3_f32 v15, v15, abs(v161), abs(v162)
    v_maximum3_f32 v15, v15, abs(v163), abs(v163)
    s_mov_b32 s60, 0x7b800000
    s_mov_b32 s59, 0x7f800000
    v_cmp_nlt_f32_e64 s[8:9], v14, s60
    v_cmp_nlt_f32_e64 vcc, v15, s59
    s_or_b64 vcc, vcc, s[8:9]
    s_cbranch_vccnz L_attn_slow_234050
L_attn_fin_234049:
    v_rcp_f32 v164, v14
    s_nop 0
    v_pk_mul_f32 v[152:153], v[152:153], v[164:165] op_sel_hi:[1,0]
    v_pk_mul_f32 v[154:155], v[154:155], v[164:165] op_sel_hi:[1,0]
    v_pk_mul_f32 v[156:157], v[156:157], v[164:165] op_sel_hi:[1,0]
    v_pk_mul_f32 v[158:159], v[158:159], v[164:165] op_sel_hi:[1,0]
    v_pk_mul_f32 v[160:161], v[160:161], v[164:165] op_sel_hi:[1,0]
    v_pk_mul_f32 v[162:163], v[162:163], v[164:165] op_sel_hi:[1,0]
    v_cvt_pk_bf16_f32 v152, v152, v153
    v_cvt_pk_bf16_f32 v153, v154, v155
    v_cvt_pk_bf16_f32 v154, v156, v157
    v_cvt_pk_bf16_f32 v155, v158, v159
    v_cvt_pk_bf16_f32 v156, v160, v161
    v_cvt_pk_bf16_f32 v157, v162, v163
    buffer_store_dwordx4 v[152:155], v16, s[4:7], s65 offen sc1
    buffer_store_dwordx2 v[156:157], v17, s[4:7], s66 offen sc1
    s_branch L_m_p3_234004
L_helpers_234001:
    s_setprio 2
    s_setprio 2
    v_lshrrev_b32 v14, 2, v1
    v_and_b32 v15, 3, v1
    v_lshlrev_b32 v16, 8, v14
    s_add_u32 s41, s43, 8192
    v_add_u32 v16, s41, v16
    v_lshl_add_u32 v17, v15, 3, v16
    v_lshl_add_u32 v16, v15, 4, v16
    v_lshlrev_b32 v18, 7, v14
    v_add_u32 v18, s43, v18
    v_lshl_add_u32 v19, v15, 3, v18
    v_bfe_u32 v14, v1, 1, 1
    v_mul_u32_u24 v14, 4080, v14
    v_add_u32 v20, v19, v14
    v_lshl_add_u32 v18, v15, 4, v18
    v_and_b32 v14, 15, v1
    v_lshlrev_b32 v14, 6, v14
    v_lshrrev_b32 v15, 4, v1
    v_lshl_add_u32 v14, v15, 4, v14
    s_lshl_b32 s41, s40, 10
    s_add_u32 s41, s41, 131072
    v_add_u32 v22, s41, v14
    s_and_b32 s55, s2, 3
    s_mul_i32 s55, s55, 56
    s_bfe_u32 s41, s2, 0x10002
    s_mul_i32 s41, s41, 28
    s_add_u32 s55, s55, s41
    s_lshr_b32 s41, s2, 3
    s_add_u32 s55, s55, s41
    s_cmp_ge_u32 s41, 28
    s_cselect_b32 s55, 255, s55
    s_mul_i32 s56, s55, 9363
    s_lshr_b32 s56, s56, 16
    s_lshl_b32 s41, s40, 2
    s_lshr_b32 s41, 0x3102, s41
    s_and_b32 s41, s41, 3
    s_mul_i32 s41, s41, 4
    s_bfe_u32 s42, s2, 0x20003
    s_mul_i32 s42, s42, 1
    s_add_u32 s41, s41, s42
    s_add_u32 s41, s41, 2
    v_mov_b32 v10, 135168
    s_mov_b32 s42, 8388608
L_m_spin_234054:
    ds_read_b32 v11, v10
    s_sub_u32 s42, s42, 1
    s_cbranch_scc1 L_m_spin_out_234055
    s_waitcnt lgkmcnt(0)
    v_cmp_gt_u32 vcc, s41, v11
    s_sleep 12
    s_cbranch_vccnz L_m_spin_234054
L_m_spin_out_234055:
    s_waitcnt lgkmcnt(0)
    s_add_u32 s54, s43, 8192
    s_mov_b32 s42, 0
    s_add_u32 s41, s54, 0
    s_mov_b32 m0, s41
    s_add_u32 s42, s42, s48
    buffer_load_dwordx4 v8, s[36:39], s42 offen lds
    s_mov_b32 s42, 0
    s_add_u32 s42, s42, s52
    s_add_u32 s41, s54, 1024
    s_mov_b32 m0, s41
    s_add_u32 s42, s42, s48
    buffer_load_dwordx4 v8, s[36:39], s42 offen lds
    s_mov_b32 s42, 0
    s_add_u32 s42, s42, s51
    s_add_u32 s41, s54, 2048
    s_mov_b32 m0, s41
    s_add_u32 s42, s42, s48
    buffer_load_dwordx4 v8, s[36:39], s42 offen lds
    s_mov_b32 s42, 0
    s_add_u32 s42, s42, s51
    s_add_u32 s42, s42, s52
    s_add_u32 s41, s54, 3072
    s_mov_b32 m0, s41
    s_add_u32 s42, s42, s48
    buffer_load_dwordx4 v8, s[36:39], s42 offen lds
    s_mov_b32 s42, 0
    s_add_u32 s42, s42, s53
    s_add_u32 s41, s54, 4096
    s_mov_b32 m0, s41
    s_add_u32 s42, s42, s48
    buffer_load_dwordx4 v8, s[36:39], s42 offen lds
    s_mov_b32 s42, 0
    s_add_u32 s42, s42, s52
    s_add_u32 s42, s42, s53
    s_add_u32 s41, s54, 5120
    s_mov_b32 m0, s41
    s_add_u32 s42, s42, s48
    buffer_load_dwordx4 v8, s[36:39], s42 offen lds
    s_mov_b32 s42, 0
    s_add_u32 s42, s42, s51
    s_add_u32 s42, s42, s53
    s_add_u32 s41, s54, 6144
    s_mov_b32 m0, s41
    s_add_u32 s42, s42, s48
    buffer_load_dwordx4 v8, s[36:39], s42 offen lds
    s_mov_b32 s42, 0
    s_add_u32 s42, s42, s51
    s_add_u32 s42, s42, s52
    s_add_u32 s42, s42, s53
    s_add_u32 s41, s54, 7168
    s_mov_b32 m0, s41
    s_add_u32 s42, s42, s48
    buffer_load_dwordx4 v8, s[36:39], s42 offen lds
    s_add_u32 s41, s43, 0
    s_mov_b32 m0, s41
    s_add_u32 s42, s44, 0
    buffer_load_dwordx4 v7, s[28:31], s42 offen lds
    s_add_u32 s41, s43, 1024
    s_mov_b32 m0, s41
    s_add_u32 s42, s44, 55296
    buffer_load_dwordx4 v7, s[28:31], s42 offen lds
    s_add_u32 s41, s43, 2048
    s_mov_b32 m0, s41
    s_add_u32 s42, s44, 13824
    buffer_load_dwordx4 v7, s[28:31], s42 offen lds
    s_add_u32 s41, s43, 3072
    s_mov_b32 m0, s41
    s_add_u32 s42, s44, 69120
    buffer_load_dwordx4 v7, s[28:31], s42 offen lds
    s_add_u32 s41, s43, 4096
    s_mov_b32 m0, s41
    s_add_u32 s42, s44, 0
    buffer_load_dwordx4 v7, s[32:35], s42 offen lds
    s_add_u32 s41, s43, 5120
    s_mov_b32 m0, s41
    s_add_u32 s42, s44, 55296
    buffer_load_dwordx4 v7, s[32:35], s42 offen lds
    s_add_u32 s41, s43, 6144
    s_mov_b32 m0, s41
    s_add_u32 s42, s44, 13824
    buffer_load_dwordx4 v7, s[32:35], s42 offen lds
    s_add_u32 s41, s43, 7168
    s_mov_b32 m0, s41
    s_add_u32 s42, s44, 69120
    buffer_load_dwordx4 v7, s[32:35], s42 offen lds
    s_waitcnt vmcnt(0)
    s_cmp_lt_u32 s47, 432
    s_cbranch_scc1 L_hlp_noB_234051
    ds_read_b64_tr_b16 v[24:25], v16 offset:0
    ds_read_b64_tr_b16 v[26:27], v16 offset:4096
    ds_read_b64_tr_b16 v[28:29], v16 offset:8
    ds_read_b64_tr_b16 v[30:31], v16 offset:4104
    ds_read_b64_tr_b16 v[32:33], v16 offset:64
    ds_read_b64_tr_b16 v[34:35], v16 offset:4160
    ds_read_b64_tr_b16 v[36:37], v16 offset:72
    ds_read_b64_tr_b16 v[38:39], v16 offset:4168
    ds_read_b64_tr_b16 v[40:41], v17 offset:128
    ds_read_b64_tr_b16 v[42:43], v17 offset:4224
    s_waitcnt lgkmcnt(8)
    buffer_store_dwordx4 v[24:27], v6, s[4:7], s49 offen offset:0 sc1
    s_waitcnt lgkmcnt(6)
    buffer_store_dwordx4 v[28:31], v6, s[4:7], s49 offen offset:1024 sc1
    s_waitcnt lgkmcnt(4)
    buffer_store_dwordx4 v[32:35], v6, s[4:7], s49 offen offset:2048 sc1
    s_waitcnt lgkmcnt(2)
    buffer_store_dwordx4 v[36:39], v6, s[4:7], s49 offen offset:3072 sc1
    s_waitcnt lgkmcnt(0)
    s_add_u32 s49, s49, 4096
    buffer_store_dwordx4 v[40:43], v6, s[4:7], s49 offen offset:0 sc1
    s_waitcnt vmcnt(0)
    s_mov_b64 exec, 1
    v_mul_u32_u24 v10, 2048, v1
    v_mov_b32 v11, 1
    buffer_atomic_add v11, v10, s[4:7], s50 offen sc1
    s_mov_b64 exec, -1
L_hlp_noB_234051:
    s_cmp_ge_u32 s47, 620
    s_cbranch_scc1 L_hlp_noG_234052
    ds_read_b64_tr_b16 v[24:25], v18 offset:0
    ds_read_b64_tr_b16 v[26:27], v18 offset:2048
    ds_read_b64_tr_b16 v[28:29], v18 offset:8
    ds_read_b64_tr_b16 v[30:31], v18 offset:2056
    ds_read_b64_tr_b16 v[32:33], v18 offset:4096
    ds_read_b64_tr_b16 v[34:35], v18 offset:6144
    ds_read_b64_tr_b16 v[36:37], v18 offset:4104
    ds_read_b64_tr_b16 v[38:39], v18 offset:6152
    ds_read_b64_tr_b16 v[40:41], v19 offset:64
    ds_read_b64_tr_b16 v[42:43], v19 offset:2112
    ds_read_b64_tr_b16 v[44:45], v19 offset:4160
    ds_read_b64_tr_b16 v[46:47], v19 offset:6208
    ds_read_b64_tr_b16 v[48:49], v20 offset:96
    ds_read_b64_tr_b16 v[50:51], v20 offset:2144
    s_waitcnt lgkmcnt(12)
    buffer_store_dwordx4 v[24:27], v6, s[4:7], s45 offen offset:0 sc1
    s_waitcnt lgkmcnt(10)
    buffer_store_dwordx4 v[28:31], v6, s[4:7], s45 offen offset:1024 sc1
    s_waitcnt lgkmcnt(8)
    buffer_store_dwordx4 v[32:35], v6, s[4:7], s45 offen offset:2048 sc1
    s_waitcnt lgkmcnt(6)
    buffer_store_dwordx4 v[36:39], v6, s[4:7], s45 offen offset:3072 sc1
    s_waitcnt lgkmcnt(4)
    s_add_u32 s45, s45, 4096
    buffer_store_dwordx4 v[40:43], v6, s[4:7], s45 offen offset:0 sc1
    s_waitcnt lgkmcnt(2)
    buffer_store_dwordx4 v[44:47], v6, s[4:7], s45 offen offset:1024 sc1
    s_waitcnt lgkmcnt(0)
    buffer_store_dwordx4 v[48:51], v6, s[4:7], s45 offen offset:2048 sc1
    s_waitcnt vmcnt(0)
    s_mov_b64 exec, 1
    v_mul_u32_u24 v10, 2048, v1
    v_mov_b32 v11, 1
    buffer_atomic_add v11, v10, s[4:7], s46 offen sc1
    s_mov_b64 exec, -1
L_hlp_noG_234052:
    v_lshlrev_b32 v14, 2, v1
    v_min_u32 v15, 31, v1
    v_lshlrev_b32 v15, 2, v15
    s_and_b32 s41, s2, 7
    s_lshl_b32 s41, s41, 11
    s_add_u32 s41, s41, 806912
    s_mov_b32 s42, 1048576
L_hlp_fm_234056:
    buffer_load_dword v10, v14, s[4:7], s41 offen offset:320 sc1
    buffer_load_dword v11, v14, s[4:7], s41 offen offset:576 sc1
    buffer_load_dword v12, v15, s[4:7], s41 offen offset:832 sc1
    s_sub_u32 s42, s42, 1
    s_cbranch_scc1 L_hlp_fmo_234057
    s_waitcnt vmcnt(0)
    v_xor_b32 v10, s21, v10
    v_xor_b32 v11, s21, v11
    v_xor_b32 v12, s21, v12
    v_or3_b32 v10, v10, v11, v12
    v_cmp_ne_u32 vcc, 0, v10
    s_sleep 8
    s_cbranch_vccnz L_hlp_fm_234056
L_hlp_fmo_234057:
    s_waitcnt vmcnt(0)
    s_bfe_u32 s42, s2, 0x20001
    s_lshl_b32 s42, s42, 3
    s_lshr_b32 s41, s2, 5
    s_add_u32 s42, s42, s41
    s_and_b32 s54, s2, 1
    s_lshl_b32 s54, s54, 2
    s_bfe_u32 s41, s2, 0x20003
    s_add_u32 s54, s54, s41
    s_cmp_lg_u32 s40, 1
    s_cbranch_scc1 L_hlp_nocoef_234058
    s_mul_i32 s41, s54, 320
    s_add_u32 s41, s41, 41984
    v_mul_u32_u24 v14, 13, v1
    v_lshrrev_b32 v14, 8, v14
    v_min_u32 v15, 1, v14
    v_add_u32 v15, v15, v14
    v_mul_u32_u24 v15, 2560, v15
    v_mul_u32_u24 v14, 320, v14
    v_sub_u32 v14, v6, v14
    v_add_u32 v14, v14, v15
    s_mov_b32 exec_hi, 0x0fffffff
    buffer_load_dwordx4 v[24:27], v14, s[4:7], s41 offen sc1
    s_add_u32 s41, s41, 15360
    buffer_load_dwordx4 v[28:31], v14, s[4:7], s41 offen sc1
    s_add_u32 s41, s41, 15360
    buffer_load_dwordx4 v[32:35], v14, s[4:7], s41 offen sc1
    s_add_u32 s41, s41, 15360
    buffer_load_dwordx4 v[36:39], v14, s[4:7], s41 offen sc1
    v_add_u32 v15, 102400, v6
    s_waitcnt vmcnt(0)
    v_add_f32 v24, v24, v28
    v_add_f32 v32, v32, v36
    v_add_f32 v25, v25, v29
    v_add_f32 v33, v33, v37
    v_add_f32 v26, v26, v30
    v_add_f32 v34, v34, v38
    v_add_f32 v27, v27, v31
    v_add_f32 v35, v35, v39
    v_add_f32 v24, v24, v32
    v_add_f32 v25, v25, v33
    v_add_f32 v26, v26, v34
    v_add_f32 v27, v27, v35
    ds_write_b128 v15, v[24:27]
    s_mov_b64 exec, -1
L_hlp_nocoef_234058:
    s_mul_i32 s41, s40, 1
    s_bfe_u32 s42, s2, 0x20003
    s_mul_i32 s42, s42, 1
    s_add_u32 s41, s41, s42
    s_add_u32 s41, s41, 12
    v_mov_b32 v10, 135168
    s_mov_b32 s42, 8388608
L_m_spin_234059:
    ds_read_b32 v11, v10
    s_sub_u32 s42, s42, 1
    s_cbranch_scc1 L_m_spin_out_234060
    s_waitcnt lgkmcnt(0)
    v_cmp_gt_u32 vcc, s41, v11
    s_sleep 12
    s_cbranch_vccnz L_m_spin_234059
L_m_spin_out_234060:
    s_waitcnt lgkmcnt(0)
    s_bfe_u32 s42, s2, 0x20001
    s_lshl_b32 s42, s42, 3
    s_lshr_b32 s41, s2, 5
    s_add_u32 s42, s42, s41
    s_and_b32 s54, s2, 1
    s_lshl_b32 s54, s54, 2
    s_bfe_u32 s41, s2, 0x20003
    s_add_u32 s54, s54, s41
    s_lshl_b32 s41, s54, 8
    s_add_u32 s41, s41, 786432
    s_mov_b64 exec, 1
    v_lshlrev_b32 v10, 8, v1
    v_mov_b32 v11, 20
    s_mov_b32 s42, 1048576
L_poll_234061:
    buffer_load_dword v12, v10, s[4:7], s41 offen sc1
    s_sub_u32 s42, s42, 1
    s_cbranch_scc1 L_poll_out_234062
    s_waitcnt vmcnt(0)
    v_cmp_gt_u32 vcc, v11, v12
    s_nop 0
    s_cbranch_vccz L_poll_out_234062
    s_sleep 16
    s_branch L_poll_234061
L_poll_out_234062:
    s_waitcnt vmcnt(0)
    s_mov_b64 exec, -1
    s_mul_i32 s54, s54, 102400
    s_add_u32 s54, s54, 24150016
    s_mul_i32 s43, s40, 25600
    s_add_u32 s54, s54, s43
    s_add_u32 s41, s43, 25600
L_hlp_wo_234063:
    s_mov_b32 m0, s43
    s_add_u32 s43, s43, 1024
    buffer_load_dwordx4 v6, s[4:7], s54 offen sc1 lds
    s_add_u32 s54, s54, 1024
    s_waitcnt vmcnt(4)
    s_cmp_lt_u32 s43, s41
    s_cbranch_scc1 L_hlp_wo_234063
    s_cmp_ge_u32 s55, 217
    s_cbranch_scc1 L_hlp_noU_234053
    s_lshl_b32 s41, s56, 8
    s_add_u32 s41, s41, 798720
    s_mov_b64 exec, 1
    v_lshlrev_b32 v10, 8, v1
    v_mov_b32 v11, 20
    s_mov_b32 s42, 1048576
L_poll_234064:
    buffer_load_dword v12, v10, s[4:7], s41 offen sc1
    s_sub_u32 s42, s42, 1
    s_cbranch_scc1 L_poll_out_234065
    s_waitcnt vmcnt(0)
    v_cmp_gt_u32 vcc, v11, v12
    s_nop 0
    s_cbranch_vccz L_poll_out_234065
    s_sleep 16
    s_branch L_poll_234064
L_poll_out_234065:
    s_waitcnt vmcnt(0)
    s_mov_b64 exec, -1
    s_mul_i32 s41, s56, 133
    s_add_u32 s41, s41, s55
    s_mul_i32 s42, s40, 35
    s_add_u32 s41, s41, s42
    s_lshl_b32 s41, s41, 10
    s_add_u32 s41, s41, 27181056
    s_mul_i32 s42, s40, 5120
    s_add_u32 s42, s42, 16384
    buffer_load_dwordx4 v[24:27], v6, s[4:7], s41 offen sc1
    buffer_load_dwordx4 v[52:55], v6, s[4:7], s42 offen sc1
    s_add_u32 s41, s41, 7168
    s_add_u32 s42, s42, 1024
    buffer_load_dwordx4 v[28:31], v6, s[4:7], s41 offen sc1
    buffer_load_dwordx4 v[56:59], v6, s[4:7], s42 offen sc1
    s_add_u32 s41, s41, 7168
    s_add_u32 s42, s42, 1024
    buffer_load_dwordx4 v[32:35], v6, s[4:7], s41 offen sc1
    buffer_load_dwordx4 v[60:63], v6, s[4:7], s42 offen sc1
    s_add_u32 s41, s41, 7168
    s_add_u32 s42, s42, 1024
    buffer_load_dwordx4 v[36:39], v6, s[4:7], s41 offen sc1
    buffer_load_dwordx4 v[64:67], v6, s[4:7], s42 offen sc1
    s_add_u32 s41, s41, 7168
    s_add_u32 s42, s42, 1024
    buffer_load_dwordx4 v[40:43], v6, s[4:7], s41 offen sc1
    buffer_load_dwordx4 v[68:71], v6, s[4:7], s42 offen sc1
    s_add_u32 s41, s41, 7168
    s_add_u32 s42, s42, 1024
    s_waitcnt vmcnt(0)
    v_mfma_f32_16x16x32_bf16 v[72:75], v[24:27], v[52:55], 0
    v_mfma_f32_16x16x32_bf16 v[72:75], v[28:31], v[56:59], v[72:75]
    v_mfma_f32_16x16x32_bf16 v[72:75], v[32:35], v[60:63], v[72:75]
    v_mfma_f32_16x16x32_bf16 v[72:75], v[36:39], v[64:67], v[72:75]
    v_mfma_f32_16x16x32_bf16 v[72:75], v[40:43], v[68:71], v[72:75]
    s_nop 7
    ds_write_b128 v22, v[72:75]
    s_mov_b64 exec, 1
    v_mov_b32 v10, 135172
    v_mov_b32 v11, 1
    s_waitcnt lgkmcnt(0)
    ds_add_rtn_u32 v11, v10, v11
    s_waitcnt lgkmcnt(0)
    v_readfirstlane_b32 s41, v11
    s_mov_b64 exec, -1
    s_cmp_lg_u32 s41, 3
    s_cbranch_scc1 L_hlp_noU_234053
    v_and_b32 v14, 15, v1
    v_lshrrev_b32 v15, 4, v1
    v_lshlrev_b32 v15, 10, v15
    v_lshl_add_u32 v15, v14, 2, v15
    v_add_u32 v15, 131072, v15
    ds_read_b32 v52, v15 offset:0
    ds_read_b32 v53, v15 offset:64
    ds_read_b32 v54, v15 offset:128
    ds_read_b32 v55, v15 offset:192
    ds_read_b32 v56, v15 offset:256
    ds_read_b32 v57, v15 offset:320
    ds_read_b32 v58, v15 offset:384
    ds_read_b32 v59, v15 offset:448
    ds_read_b32 v60, v15 offset:512
    ds_read_b32 v61, v15 offset:576
    ds_read_b32 v62, v15 offset:640
    ds_read_b32 v63, v15 offset:704
    ds_read_b32 v64, v15 offset:768
    ds_read_b32 v65, v15 offset:832
    ds_read_b32 v66, v15 offset:896
    ds_read_b32 v67, v15 offset:960
    s_waitcnt lgkmcnt(0)
    v_add_f32 v52, v52, v56
    v_add_f32 v60, v60, v64
    v_add_f32 v53, v53, v57
    v_add_f32 v61, v61, v65
    v_add_f32 v54, v54, v58
    v_add_f32 v62, v62, v66
    v_add_f32 v55, v55, v59
    v_add_f32 v63, v63, v67
    v_add_f32 v52, v52, v54
    v_add_f32 v60, v60, v62
    v_add_f32 v53, v53, v55
    v_add_f32 v61, v61, v63
    v_add_f32 v72, v52, v53
    v_add_f32 v74, v60, v61
    v_mov_b32 v73, v72
    v_mov_b32 v75, v74
    s_nop 1
    v_permlane32_swap_b32 v72, v73
    v_permlane32_swap_b32 v74, v75
    s_nop 0
    v_add_f32 v72, v72, v73
    v_add_f32 v74, v74, v75
    v_mov_b32 v73, v72
    v_mov_b32 v75, v74
    s_nop 1
    v_permlane16_swap_b32 v72, v73
    v_permlane16_swap_b32 v74, v75
    s_nop 0
    v_add_f32 v72, v72, v73
    v_add_f32 v74, v74, v75
    v_cvt_pk_bf16_f32 v24, v72, v72
    v_cvt_pk_bf16_f32 v28, v74, v74
    v_and_b32 v73, 0xffff0000, v24
    v_and_b32 v75, 0xffff0000, v28
    v_sub_f32 v72, v72, v73
    v_sub_f32 v74, v74, v75
    v_cvt_pk_bf16_f32 v25, v72, v75
    v_cvt_pk_bf16_f32 v26, v75, v74
    v_mov_b32 v27, 0
    v_lshlrev_b32 v14, 4, v14
    s_lshl_b32 s41, s55, 8
    s_add_u32 s41, s41, 851968
    s_mov_b64 exec, 0xffff
    buffer_store_dwordx4 v[24:27], v14, s[4:7], s41 offen sc1
    s_mov_b64 exec, -1
    s_lshl_b32 s41, s56, 8
    s_add_u32 s41, s41, 790528
    s_waitcnt vmcnt(0)
    s_mov_b64 exec, 1
    v_mul_u32_u24 v10, 2048, v1
    v_mov_b32 v11, 1
    buffer_atomic_add v11, v10, s[4:7], s41 offen sc1
    s_mov_b64 exec, -1
L_hlp_noU_234053:
    s_bfe_u32 s42, s2, 0x10002
    s_lshl_b32 s42, s42, 2
    s_bfe_u32 s41, s2, 0x20003
    s_add_u32 s42, s42, s41
    s_and_b32 s54, s2, 3
    s_lshl_b32 s54, s54, 3
    s_lshr_b32 s41, s2, 5
    s_add_u32 s54, s54, s41
    s_cmp_ge_u32 s54, 31
    s_cbranch_scc1 L_hlp_nogu0_234066
    s_cmp_lg_u32 s40, 1
    s_cbranch_scc1 L_hlp_nogu0_234066
    s_lshl_b32 s41, s54, 8
    s_add_u32 s41, s41, 798720
    s_mov_b64 exec, 1
    v_lshlrev_b32 v10, 8, v1
    v_mov_b32 v11, 20
    s_mov_b32 s42, 1048576
L_poll_234067:
    buffer_load_dword v12, v10, s[4:7], s41 offen sc1
    s_sub_u32 s42, s42, 1
    s_cbranch_scc1 L_poll_out_234068
    s_waitcnt vmcnt(0)
    v_cmp_gt_u32 vcc, v11, v12
    s_nop 0
    s_cbranch_vccz L_poll_out_234068
    s_sleep 16
    s_branch L_poll_234067
L_poll_out_234068:
    s_waitcnt vmcnt(0)
    s_mov_b64 exec, -1
L_hlp_nogu0_234066:
    s_waitcnt vmcnt(0) lgkmcnt(0)
    s_setprio 0
    s_barrier
L_m_p3_234004:
    s_waitcnt vmcnt(0)
    s_barrier
    s_cmp_lg_u32 s10, 0
    s_cbranch_scc1 L_m_nosig_234069
    s_lshr_b32 s22, s2, 5
    s_and_b32 s23, s22, 6
    s_mul_i32 s23, s23, 2048
    s_mul_i32 s22, s22, 16384
    s_add_u32 s22, s22, s23
    s_and_b32 s23, s2, 3
    s_lshl_b32 s23, s23, 8
    s_add_u32 s22, s22, s23
    s_add_u32 s22, s22, 262144
    s_mov_b64 exec, 3
    v_mul_u32_u24 v2, 2048, v1
    v_mov_b32 v3, 1
    buffer_atomic_add v3, v2, s[4:7], s22 offen sc1
    s_mov_b64 exec, -1
L_m_nosig_234069:
    s_bfe_u32 s30, s2, 0x20001
    s_lshl_b32 s30, s30, 3
    s_lshr_b32 s32, s2, 5
    s_add_u32 s30, s30, s32
    s_and_b32 s31, s2, 1
    s_lshl_b32 s31, s31, 2
    s_bfe_u32 s32, s2, 0x20003
    s_add_u32 s31, s31, s32
    s_bfe_u32 s34, s10, 0x10001
    s_lshr_b32 s35, s10, 2
    s_lshl_b32 s39, s35, 3
    s_lshl_b32 s35, s35, 1
    s_and_b32 s32, s10, 1
    s_add_u32 s35, s35, s32
    s_add_u32 s39, s39, s32
    s_and_b32 s32, s30, 3
    s_lshl_b32 s32, s32, 1
    s_add_u32 s39, s39, s32
    s_lshr_b32 s32, s30, 2
    s_lshl_b32 s32, s32, 4
    s_add_u32 s39, s39, s32
    v_lshlrev_b32 v30, 4, v1
    v_and_b32 v36, 15, v1
    v_lshrrev_b32 v37, 4, v1
    v_lshlrev_b32 v34, 5, v37
    v_lshlrev_b32 v35, 4, v37
    v_lshlrev_b32 v40, 8, v37
    v_lshl_add_u32 v40, v36, 3, v40
    s_lshl_b32 s32, s34, 7
    s_add_u32 s32, s32, 102400
    v_add_u32 v34, s32, v34
    v_add_u32 v35, 102656, v35
    ds_read_b128 v[168:171], v34 offset:0
    ds_read_b128 v[172:175], v34 offset:16
    ds_read_b128 v[176:179], v35 offset:0
    ds_read_b128 v[180:183], v34 offset:320
    ds_read_b128 v[184:187], v34 offset:336
    ds_read_b128 v[188:191], v35 offset:320
    ds_read_b128 v[16:19], v34 offset:640
    ds_read_b128 v[20:23], v34 offset:656
    ds_read_b128 v[24:27], v35 offset:640
    s_mul_i32 s38, s39, 20480
    s_mul_i32 s37, s31, 160
    s_add_u32 s38, s38, s37
    v_mul_u32_u24 v38, 1280, v36
    v_add_u32 v38, s38, v38
    v_lshl_add_u32 v39, v37, 3, v38
    v_add_u32 v39, 128, v39
    v_lshl_add_u32 v38, v37, 4, v38
    s_lshl_b32 s37, s34, 6
    v_add_u32 v38, s37, v38
    s_mul_i32 s38, s39, 20
    s_add_u32 s38, s38, s34
    s_lshl_b32 s38, s38, 10
    s_add_u32 s38, s38, 9371648
    s_add_u32 s42, s38, 4096
    s_add_u32 s42, s42, s4
    s_addc_u32 s43, s5, 0
    s_mul_i32 s32, s34, 7168
    v_add_u32 v31, s32, v30
    s_mul_i32 s32, s34, 3072
    s_add_u32 s32, s32, 2048
    v_add_u32 v32, s32, v30
    s_mul_i32 s32, s34, 5120
    s_add_u32 s32, s32, 4096
    v_add_u32 v33, s32, v30
    v_lshlrev_b32 v28, 4, v1
    s_bfe_u32 s25, s2, 0x10002
    s_lshl_b32 s25, s25, 2
    s_bfe_u32 s22, s2, 0x20003
    s_add_u32 s25, s25, s22
    s_and_b32 s24, s2, 3
    s_lshl_b32 s24, s24, 3
    s_lshr_b32 s22, s2, 5
    s_add_u32 s24, s24, s22
    s_cmp_ge_u32 s24, 31
    s_mul_i32 s24, s24, 143360
    s_cselect_b32 s25, 0x40000000, 27181056
    s_add_u32 s24, s24, s25
    s_cmp_eq_u32 s10, 0
    s_cbranch_scc1 L_proj_w0_234071
    buffer_load_dwordx4 v[8:11], v38, s[12:15], 0 offen
    buffer_load_dwordx2 v[14:15], v39, s[12:15], 0 offen
    s_add_u32 s25, s10, 83
    s_lshl_b32 s25, s25, 10
    s_add_u32 s22, s24, s25
    s_add_u32 s23, s25, 20480
    s_mov_b32 m0, s23
    s_add_u32 s23, s23, 7168
    buffer_load_dwordx4 v28, s[4:7], s22 offen sc1 lds
    s_add_u32 s22, s22, 7168
    s_mov_b32 m0, s23
    s_add_u32 s23, s23, 7168
    buffer_load_dwordx4 v28, s[4:7], s22 offen sc1 lds
    s_add_u32 s22, s22, 7168
    s_mov_b32 m0, s23
    s_add_u32 s23, s23, 7168
    buffer_load_dwordx4 v28, s[4:7], s22 offen sc1 lds
    s_add_u32 s22, s22, 7168
    s_mov_b32 m0, s23
    s_add_u32 s23, s23, 7168
    buffer_load_dwordx4 v28, s[4:7], s22 offen sc1 lds
    s_add_u32 s22, s22, 7168
    s_mov_b32 m0, s23
    s_add_u32 s23, s23, 7168
    buffer_load_dwordx4 v28, s[4:7], s22 offen sc1 lds
    s_add_u32 s22, s22, 7168
    s_mov_b32 m0, s23
    s_add_u32 s23, s23, 7168
    buffer_load_dwordx4 v28, s[4:7], s22 offen sc1 lds
    s_add_u32 s22, s22, 7168
    s_mov_b32 m0, s23
    s_add_u32 s23, s23, 7168
    buffer_load_dwordx4 v28, s[4:7], s22 offen sc1 lds
    s_add_u32 s22, s22, 7168
    s_mov_b32 m0, s23
    s_add_u32 s23, s23, 7168
    buffer_load_dwordx4 v28, s[4:7], s22 offen sc1 lds
    s_add_u32 s22, s22, 7168
    s_branch L_proj_nopoll_234070
L_proj_w0_234071:
    s_cmp_lg_u32 s10, 0
    s_cbranch_scc1 L_proj_nopoll_234070
    s_lshr_b32 s32, s30, 2
    s_mul_i32 s32, s32, 16384
    s_bfe_u32 s33, s2, 196608
    s_mul_i32 s33, s33, 2048
    s_add_u32 s32, s32, s33
    s_add_u32 s32, s32, 262144
    s_bfe_u32 s33, s2, 0x10002
    s_lshl_b32 s33, s33, 2
    s_bfe_u32 s36, s2, 0x20003
    s_add_u32 s33, s33, s36
    s_and_b32 s40, s2, 3
    s_lshl_b32 s40, s40, 3
    s_lshr_b32 s36, s2, 5
    s_add_u32 s40, s40, s36
    s_cmp_ge_u32 s40, 31
    s_cselect_b32 s37, 0, 7
    s_lshl_b32 s36, s40, 8
    s_add_u32 s36, s36, 790528
    s_mov_b64 exec, 31
    v_lshlrev_b32 v42, 8, v1
    v_mov_b32 v43, 8
    s_mov_b32 s33, 1048576
    s_sub_u32 s36, s36, s32
    v_writelane_b32 v42, s36, 4
    v_writelane_b32 v43, s37, 4
L_poll_234072:
    buffer_load_dword v44, v42, s[4:7], s32 offen sc1
    s_sub_u32 s33, s33, 1
    s_cbranch_scc1 L_poll_out_234073
    s_waitcnt vmcnt(0)
    v_cmp_gt_u32 vcc, v43, v44
    s_nop 0
    s_cbranch_vccz L_poll_out_234073
    s_sleep 0
    s_branch L_poll_234072
L_poll_out_234073:
    s_waitcnt vmcnt(0)
    s_mov_b64 exec, -1
    s_cmp_lg_u32 s2, 0
    s_cbranch_scc1 L_m_noepoch_234074
    s_mov_b64 exec, 1
    v_mov_b32 v42, 0
    v_mov_b32 v43, s21
    buffer_store_dword v43, v42, s[4:7], 0 offen sc1
    s_mov_b64 exec, -1
L_m_noepoch_234074:
    buffer_load_dwordx4 v[8:11], v38, s[12:15], 0 offen
    buffer_load_dwordx2 v[14:15], v39, s[12:15], 0 offen
    s_branch L_proj_bar_234075
L_proj_nopoll_234070:
    s_waitcnt vmcnt(0)
L_proj_bar_234075:
    s_waitcnt lgkmcnt(0)
    s_barrier
    buffer_load_dwordx4 v[48:51], v30, s[4:7], s38 offen offset:0 sc1
    buffer_load_dwordx4 v[52:55], v30, s[4:7], s38 offen offset:2048 sc1
    s_add_u32 s38, s38, 4096
    buffer_load_dwordx4 v[56:59], v30, s[4:7], s38 offen offset:0 sc1
    buffer_load_dwordx4 v[60:63], v30, s[4:7], s38 offen offset:2048 sc1
    s_add_u32 s38, s38, 4096
    buffer_load_dwordx4 v[64:67], v30, s[4:7], s38 offen offset:0 sc1
    buffer_load_dwordx4 v[68:71], v30, s[4:7], s38 offen offset:2048 sc1
    s_add_u32 s38, s38, 4096
    buffer_load_dwordx4 v[72:75], v30, s[4:7], s38 offen offset:0 sc1
    buffer_load_dwordx4 v[76:79], v30, s[4:7], s38 offen offset:2048 sc1
    s_add_u32 s38, s38, 4096
    buffer_load_dwordx2 v[80:81], v40, s[4:7], s38 offen offset:0 sc1
    buffer_load_dwordx2 v[82:83], v40, s[4:7], s38 offen offset:128 sc1
    buffer_load_dwordx2 v[84:85], v40, s[4:7], s38 offen offset:2048 sc1
    buffer_load_dwordx2 v[86:87], v40, s[4:7], s38 offen offset:2176 sc1
    s_add_u32 s38, s38, 4096
    ds_read_b128 v[88:91], v31 offset:0
    ds_read_b128 v[92:95], v31 offset:1024
    ds_read_b128 v[96:99], v32 offset:0
    ds_read_b128 v[100:103], v32 offset:1024
    ds_read_b128 v[104:107], v33 offset:0
    ds_read_b128 v[108:111], v31 offset:10240
    ds_read_b128 v[112:115], v31 offset:11264
    ds_read_b128 v[116:119], v32 offset:10240
    ds_read_b128 v[120:123], v32 offset:11264
    ds_read_b128 v[124:127], v33 offset:10240
    s_waitcnt vmcnt(11) lgkmcnt(5)
    v_mfma_f32_16x16x32_bf16 v[148:151], v[88:91], v[48:51], 0
    ds_read_b128 v[128:131], v31 offset:20480
    v_mfma_f32_16x16x32_bf16 v[152:155], v[92:95], v[48:51], 0
    ds_read_b128 v[132:135], v31 offset:21504
    v_mfma_f32_16x16x32_bf16 v[156:159], v[96:99], v[48:51], 0
    ds_read_b128 v[136:139], v32 offset:20480
    v_mfma_f32_16x16x32_bf16 v[160:163], v[100:103], v[48:51], 0
    ds_read_b128 v[140:143], v32 offset:21504
    v_mfma_f32_16x16x32_bf16 v[164:167], v[104:107], v[48:51], 0
    ds_read_b128 v[144:147], v33 offset:20480
    s_waitcnt vmcnt(10) lgkmcnt(5)
    v_mfma_f32_16x16x32_bf16 v[148:151], v[108:111], v[52:55], v[148:151]
    ds_read_b128 v[88:91], v31 offset:30720
    v_mfma_f32_16x16x32_bf16 v[152:155], v[112:115], v[52:55], v[152:155]
    ds_read_b128 v[92:95], v31 offset:31744
    v_mfma_f32_16x16x32_bf16 v[156:159], v[116:119], v[52:55], v[156:159]
    ds_read_b128 v[96:99], v32 offset:30720
    v_mfma_f32_16x16x32_bf16 v[160:163], v[120:123], v[52:55], v[160:163]
    ds_read_b128 v[100:103], v32 offset:31744
    v_mfma_f32_16x16x32_bf16 v[164:167], v[124:127], v[52:55], v[164:167]
    ds_read_b128 v[104:107], v33 offset:30720
    s_waitcnt vmcnt(9) lgkmcnt(5)
    v_mfma_f32_16x16x32_bf16 v[148:151], v[128:131], v[56:59], v[148:151]
    ds_read_b128 v[108:111], v31 offset:40960
    v_mfma_f32_16x16x32_bf16 v[152:155], v[132:135], v[56:59], v[152:155]
    ds_read_b128 v[112:115], v31 offset:41984
    v_mfma_f32_16x16x32_bf16 v[156:159], v[136:139], v[56:59], v[156:159]
    ds_read_b128 v[116:119], v32 offset:40960
    v_mfma_f32_16x16x32_bf16 v[160:163], v[140:143], v[56:59], v[160:163]
    ds_read_b128 v[120:123], v32 offset:41984
    v_mfma_f32_16x16x32_bf16 v[164:167], v[144:147], v[56:59], v[164:167]
    ds_read_b128 v[124:127], v33 offset:40960
    v_add_u32 v31, 51200, v31
    v_add_u32 v32, 51200, v32
    v_add_u32 v33, 51200, v33
    s_waitcnt vmcnt(8) lgkmcnt(5)
    v_mfma_f32_16x16x32_bf16 v[148:151], v[88:91], v[60:63], v[148:151]
    ds_read_b128 v[128:131], v31 offset:0
    v_mfma_f32_16x16x32_bf16 v[152:155], v[92:95], v[60:63], v[152:155]
    ds_read_b128 v[132:135], v31 offset:1024
    v_mfma_f32_16x16x32_bf16 v[156:159], v[96:99], v[60:63], v[156:159]
    ds_read_b128 v[136:139], v32 offset:0
    v_mfma_f32_16x16x32_bf16 v[160:163], v[100:103], v[60:63], v[160:163]
    ds_read_b128 v[140:143], v32 offset:1024
    v_mfma_f32_16x16x32_bf16 v[164:167], v[104:107], v[60:63], v[164:167]
    ds_read_b128 v[144:147], v33 offset:0
    s_waitcnt vmcnt(7) lgkmcnt(5)
    v_mfma_f32_16x16x32_bf16 v[148:151], v[108:111], v[64:67], v[148:151]
    ds_read_b128 v[88:91], v31 offset:10240
    v_mfma_f32_16x16x32_bf16 v[152:155], v[112:115], v[64:67], v[152:155]
    ds_read_b128 v[92:95], v31 offset:11264
    v_mfma_f32_16x16x32_bf16 v[156:159], v[116:119], v[64:67], v[156:159]
    ds_read_b128 v[96:99], v32 offset:10240
    v_mfma_f32_16x16x32_bf16 v[160:163], v[120:123], v[64:67], v[160:163]
    ds_read_b128 v[100:103], v32 offset:11264
    v_mfma_f32_16x16x32_bf16 v[164:167], v[124:127], v[64:67], v[164:167]
    ds_read_b128 v[104:107], v33 offset:10240
    s_waitcnt vmcnt(6) lgkmcnt(5)
    v_mfma_f32_16x16x32_bf16 v[148:151], v[128:131], v[68:71], v[148:151]
    ds_read_b128 v[108:111], v31 offset:20480
    v_mfma_f32_16x16x32_bf16 v[152:155], v[132:135], v[68:71], v[152:155]
    ds_read_b128 v[112:115], v31 offset:21504
    v_mfma_f32_16x16x32_bf16 v[156:159], v[136:139], v[68:71], v[156:159]
    ds_read_b128 v[116:119], v32 offset:20480
    v_mfma_f32_16x16x32_bf16 v[160:163], v[140:143], v[68:71], v[160:163]
    ds_read_b128 v[120:123], v32 offset:21504
    v_mfma_f32_16x16x32_bf16 v[164:167], v[144:147], v[68:71], v[164:167]
    ds_read_b128 v[124:127], v33 offset:20480
    s_waitcnt vmcnt(5) lgkmcnt(5)
    v_mfma_f32_16x16x32_bf16 v[148:151], v[88:91], v[72:75], v[148:151]
    ds_read_b128 v[128:131], v31 offset:30720
    v_mfma_f32_16x16x32_bf16 v[152:155], v[92:95], v[72:75], v[152:155]
    ds_read_b128 v[132:135], v31 offset:31744
    v_mfma_f32_16x16x32_bf16 v[156:159], v[96:99], v[72:75], v[156:159]
    ds_read_b128 v[136:139], v32 offset:30720
    v_mfma_f32_16x16x32_bf16 v[160:163], v[100:103], v[72:75], v[160:163]
    ds_read_b128 v[140:143], v32 offset:31744
    v_mfma_f32_16x16x32_bf16 v[164:167], v[104:107], v[72:75], v[164:167]
    ds_read_b128 v[144:147], v33 offset:30720
    s_waitcnt vmcnt(4) lgkmcnt(5)
    v_mfma_f32_16x16x32_bf16 v[148:151], v[108:111], v[76:79], v[148:151]
    ds_read_b128 v[88:91], v31 offset:40960
    v_mfma_f32_16x16x32_bf16 v[152:155], v[112:115], v[76:79], v[152:155]
    ds_read_b128 v[92:95], v31 offset:41984
    v_mfma_f32_16x16x32_bf16 v[156:159], v[116:119], v[76:79], v[156:159]
    ds_read_b128 v[96:99], v32 offset:40960
    v_mfma_f32_16x16x32_bf16 v[160:163], v[120:123], v[76:79], v[160:163]
    ds_read_b128 v[100:103], v32 offset:41984
    v_mfma_f32_16x16x32_bf16 v[164:167], v[124:127], v[76:79], v[164:167]
    ds_read_b128 v[104:107], v33 offset:40960
    s_waitcnt vmcnt(2) lgkmcnt(5)
    v_mfma_f32_16x16x32_bf16 v[148:151], v[128:131], v[80:83], v[148:151]
    v_mfma_f32_16x16x32_bf16 v[152:155], v[132:135], v[80:83], v[152:155]
    v_mfma_f32_16x16x32_bf16 v[156:159], v[136:139], v[80:83], v[156:159]
    v_mfma_f32_16x16x32_bf16 v[160:163], v[140:143], v[80:83], v[160:163]
    v_mfma_f32_16x16x32_bf16 v[164:167], v[144:147], v[80:83], v[164:167]
    s_waitcnt vmcnt(0) lgkmcnt(0)
    v_mfma_f32_16x16x32_bf16 v[148:151], v[88:91], v[84:87], v[148:151]
    v_mfma_f32_16x16x32_bf16 v[152:155], v[92:95], v[84:87], v[152:155]
    v_mfma_f32_16x16x32_bf16 v[156:159], v[96:99], v[84:87], v[156:159]
    v_mfma_f32_16x16x32_bf16 v[160:163], v[100:103], v[84:87], v[160:163]
    v_mfma_f32_16x16x32_bf16 v[164:167], v[104:107], v[84:87], v[164:167]
    s_barrier
    s_lshl_b32 s32, s35, 11
    s_mul_i32 s33, s35, 3072
    s_add_u32 s33, s33, 8192
    s_cmp_eq_u32 s34, 0
    s_cselect_b32 s37, s32, s33
    s_cselect_b32 s36, s33, s32
    v_add_u32 v31, s37, v30
    v_add_u32 v32, s36, v30
    ds_write_b128 v31, v[156:159]
    ds_write_b128 v31, v[160:163] offset:1024
    s_cbranch_scc1 L_proj_k2_234077
    ds_write_b128 v31, v[164:167] offset:2048
L_proj_k2_234077:
    v_lshlrev_b32 v4, 16, v8
    v_and_b32 v5, 0xffff0000, v8
    v_lshlrev_b32 v6, 16, v9
    v_and_b32 v7, 0xffff0000, v9
    v_lshlrev_b32 v8, 16, v10
    v_and_b32 v9, 0xffff0000, v10
    v_lshlrev_b32 v10, 16, v11
    v_and_b32 v11, 0xffff0000, v11
    v_lshlrev_b32 v12, 16, v14
    v_and_b32 v13, 0xffff0000, v14
    v_lshlrev_b32 v14, 16, v15
    v_and_b32 v15, 0xffff0000, v15
    s_waitcnt lgkmcnt(0)
    s_barrier
    ds_read_b128 v[88:91], v32 offset:0
    ds_read_b128 v[92:95], v32 offset:1024
    ds_read_b128 v[96:99], v32 offset:2048
    s_add_u32 s25, s10, 0
    s_lshl_b32 s25, s25, 10
    s_add_u32 s22, s24, s25
    s_add_u32 s23, s25, 20480
    s_mov_b32 m0, s23
    s_add_u32 s23, s23, 8192
    buffer_load_dwordx4 v28, s[4:7], s22 offen sc1 lds
    s_add_u32 s22, s22, 8192
    s_mov_b32 m0, s23
    s_add_u32 s23, s23, 8192
    buffer_load_dwordx4 v28, s[4:7], s22 offen sc1 lds
    s_add_u32 s22, s22, 8192
    s_waitcnt lgkmcnt(1)
    v_add_f32 v148, v148, v88
    v_add_f32 v149, v149, v89
    v_add_f32 v150, v150, v90
    v_add_f32 v151, v151, v91
    v_add_f32 v152, v152, v92
    v_add_f32 v153, v153, v93
    v_add_f32 v154, v154, v94
    v_add_f32 v155, v155, v95
    v_fma_f32 v4, v148, v168, v4
    v_fma_f32 v5, v149, v169, v5
    v_fma_f32 v6, v150, v170, v6
    v_fma_f32 v7, v151, v171, v7
    v_fma_f32 v8, v152, v172, v8
    v_fma_f32 v9, v153, v173, v9
    v_fma_f32 v10, v154, v174, v10
    v_fma_f32 v11, v155, v175, v11
    v_mul_f32 v180, v180, v4
    v_mul_f32 v181, v181, v5
    v_mul_f32 v182, v182, v6
    v_mul_f32 v183, v183, v7
    v_mul_f32 v184, v184, v8
    v_mul_f32 v185, v185, v9
    v_mul_f32 v186, v186, v10
    v_mul_f32 v187, v187, v11
    v_cvt_pk_bf16_f32 v108, v180, v181
    v_cvt_pk_bf16_f32 v109, v182, v183
    v_cvt_pk_bf16_f32 v110, v184, v185
    v_cvt_pk_bf16_f32 v111, v186, v187
    s_mul_i32 s32, s39, 20480
    s_mul_i32 s33, s31, 2560
    s_add_u32 s32, s32, s33
    s_add_u32 s32, s32, 11993088
    s_lshl_b32 s33, s34, 10
    s_add_u32 s33, s33, s32
    buffer_store_dwordx4 v[108:111], v30, s[4:7], s33 offen sc1
    v_mul_f32 v169, v4, v4
    v_add_f32 v168, v4, v5
    v_fmac_f32 v169, v5, v5
    v_add_f32 v168, v168, v6
    v_fmac_f32 v169, v6, v6
    v_add_f32 v168, v168, v7
    v_fmac_f32 v169, v7, v7
    v_add_f32 v168, v168, v8
    v_fmac_f32 v169, v8, v8
    v_add_f32 v168, v168, v9
    v_fmac_f32 v169, v9, v9
    v_add_f32 v168, v168, v10
    v_fmac_f32 v169, v10, v10
    v_add_f32 v168, v168, v11
    v_fmac_f32 v169, v11, v11
    s_cmp_lg_u32 s34, 0
    s_cbranch_scc1 L_proj_k1_234076
    s_waitcnt lgkmcnt(0)
    v_add_f32 v164, v164, v96
    v_add_f32 v165, v165, v97
    v_add_f32 v166, v166, v98
    v_add_f32 v167, v167, v99
    v_fma_f32 v12, v164, v176, v12
    v_fma_f32 v13, v165, v177, v13
    v_fma_f32 v14, v166, v178, v14
    v_fma_f32 v15, v167, v179, v15
    v_mul_f32 v188, v188, v12
    v_mul_f32 v189, v189, v13
    v_mul_f32 v190, v190, v14
    v_mul_f32 v191, v191, v15
    v_cvt_pk_bf16_f32 v112, v188, v189
    v_cvt_pk_bf16_f32 v113, v190, v191
    v_lshrrev_b32 v34, 1, v37
    v_lshlrev_b32 v34, 8, v34
    v_lshl_add_u32 v34, v36, 4, v34
    v_and_b32 v35, 1, v37
    v_lshl_add_u32 v34, v35, 3, v34
    buffer_store_dwordx2 v[112:113], v34, s[4:7], s32 offen offset:2048 sc1
    v_add_f32 v168, v168, v12
    v_fmac_f32 v169, v12, v12
    v_add_f32 v168, v168, v13
    v_fmac_f32 v169, v13, v13
    v_add_f32 v168, v168, v14
    v_fmac_f32 v169, v14, v14
    v_add_f32 v168, v168, v15
    v_fmac_f32 v169, v15, v15
L_proj_k1_234076:
    v_mov_b32 v170, v168
    v_mov_b32 v171, v169
    s_nop 1
    v_permlane32_swap_b32 v168, v170
    v_permlane32_swap_b32 v169, v171
    s_nop 0
    v_add_f32 v168, v168, v170
    v_add_f32 v169, v169, v171
    v_mov_b32 v170, v168
    v_mov_b32 v171, v169
    s_nop 1
    v_permlane16_swap_b32 v168, v170
    v_permlane16_swap_b32 v169, v171
    s_nop 0
    v_add_f32 v168, v168, v170
    v_add_f32 v169, v169, v171
    s_lshl_b32 s32, s31, 8
    s_lshl_b32 s33, s34, 7
    s_add_u32 s32, s32, s33
    s_lshl_b32 s33, s39, 11
    s_add_u32 s32, s32, s33
    s_add_u32 s32, s32, 1114112
    v_lshlrev_b32 v34, 3, v36
    s_mov_b64 exec, 0xffff
    buffer_store_dwordx2 v[168:169], v34, s[4:7], s32 offen sc1
    s_mov_b64 exec, -1
    s_waitcnt lgkmcnt(0)
    s_lshr_b32 s32, s30, 2
    s_and_b32 s33, s32, 4
    s_mul_i32 s33, s33, 2048
    s_mul_i32 s20, s32, 16384
    s_add_u32 s20, s20, s33
    s_and_b32 s33, s31, 3
    s_lshl_b32 s33, s33, 8
    s_add_u32 s20, s20, s33
    s_add_u32 s20, s20, 393216
    s_bfe_u32 s30, s2, 0x10002
    s_lshl_b32 s30, s30, 2
    s_bfe_u32 s32, s2, 0x20003
    s_add_u32 s30, s30, s32
    s_and_b32 s31, s2, 3
    s_lshl_b32 s31, s31, 3
    s_lshr_b32 s32, s2, 5
    s_add_u32 s31, s31, s32
    v_lshlrev_b32 v30, 4, v1
    v_and_b32 v34, 15, v1
    v_lshrrev_b32 v35, 4, v1
    s_mov_b32 m0, s23
    s_add_u32 s23, s23, 8192
    buffer_load_dwordx4 v28, s[4:7], s22 offen sc1 lds
    s_add_u32 s22, s22, 8192
    s_mov_b32 m0, s23
    s_add_u32 s23, s23, 8192
    buffer_load_dwordx4 v28, s[4:7], s22 offen sc1 lds
    s_add_u32 s22, s22, 8192
    s_mov_b32 m0, s23
    s_add_u32 s23, s23, 8192
    buffer_load_dwordx4 v28, s[4:7], s22 offen sc1 lds
    s_add_u32 s22, s22, 8192
    s_waitcnt vmcnt(3)
    s_barrier
    s_cmp_eq_u32 s10, 0
    s_cbranch_scc1 L_gu_w0b_234080
    s_add_u32 s25, s10, 39
    s_lshl_b32 s25, s25, 10
    s_add_u32 s22, s24, s25
    s_add_u32 s23, s25, 20480
    s_mov_b32 m0, s23
    s_add_u32 s23, s23, 7168
    buffer_load_dwordx4 v28, s[4:7], s22 offen sc1 lds
    s_add_u32 s22, s22, 7168
    s_mov_b32 m0, s23
    s_add_u32 s23, s23, 7168
    buffer_load_dwordx4 v28, s[4:7], s22 offen sc1 lds
    s_add_u32 s22, s22, 7168
    s_mov_b32 m0, s23
    s_add_u32 s23, s23, 7168
    buffer_load_dwordx4 v28, s[4:7], s22 offen sc1 lds
    s_add_u32 s22, s22, 7168
    s_mov_b32 m0, s23
    s_add_u32 s23, s23, 7168
    buffer_load_dwordx4 v28, s[4:7], s22 offen sc1 lds
    s_add_u32 s22, s22, 7168
    s_mov_b32 m0, s23
    s_add_u32 s23, s23, 7168
    buffer_load_dwordx4 v28, s[4:7], s22 offen sc1 lds
    s_add_u32 s22, s22, 7168
    s_mov_b32 m0, s23
    s_add_u32 s23, s23, 7168
    buffer_load_dwordx4 v28, s[4:7], s22 offen sc1 lds
    s_add_u32 s22, s22, 7168
    s_cmp_ge_u32 s10, 3
    s_cbranch_scc1 L_feed_skip_234082
    s_mov_b32 m0, s23
    s_add_u32 s23, s23, 7168
    buffer_load_dwordx4 v28, s[4:7], s22 offen sc1 lds
    s_add_u32 s22, s22, 7168
L_feed_skip_234082:
    s_waitcnt vmcnt(0)
    s_branch L_gu_w0c_234081
L_gu_w0b_234080:
    s_mov_b64 exec, 15
    v_mul_u32_u24 v36, 2048, v1
    v_mov_b32 v37, 1
    buffer_atomic_add v37, v36, s[4:7], s20 offen sc1
    s_mov_b64 exec, -1
    s_bfe_u32 s32, s2, 0x20001
    s_lshl_b32 s32, s32, 3
    s_lshr_b32 s33, s2, 5
    s_add_u32 s32, s32, s33
    s_and_b32 s34, s2, 1
    s_lshl_b32 s34, s34, 2
    s_bfe_u32 s33, s2, 0x20003
    s_add_u32 s34, s34, s33
    s_lshl_b32 s34, s34, 8
    s_add_u32 s34, s34, 788480
    s_mul_i32 s32, s30, 16384
    s_bfe_u32 s33, s2, 196608
    s_mul_i32 s33, s33, 2048
    s_add_u32 s32, s32, s33
    s_add_u32 s32, s32, 393216
    s_mov_b64 exec, 31
    v_lshlrev_b32 v36, 8, v1
    v_mov_b32 v37, 8
    s_mov_b32 s33, 1048576
    s_sub_u32 s34, s34, s32
    v_writelane_b32 v36, s34, 4
    v_writelane_b32 v37, 54, 4
L_poll_234083:
    buffer_load_dword v38, v36, s[4:7], s32 offen sc1
    s_sub_u32 s33, s33, 1
    s_cbranch_scc1 L_poll_out_234084
    s_waitcnt vmcnt(0)
    v_cmp_gt_u32 vcc, v37, v38
    s_nop 0
    s_cbranch_vccz L_poll_out_234084
    s_sleep 0
    s_branch L_poll_234083
L_poll_out_234084:
    s_waitcnt vmcnt(0)
    s_mov_b64 exec, -1
L_gu_w0c_234081:
    v_add_u32 v31, 20480, v30
    s_lshl_b32 s38, s30, 3
    s_add_u32 s38, s38, s10
    s_lshl_b32 s38, s38, 1
    s_mul_i32 s36, s38, 20480
    s_add_u32 s36, s36, 11993088
    s_add_u32 s37, s36, 20480
    s_add_u32 s42, s36, 4096
    s_add_u32 s42, s42, s4
    s_addc_u32 s43, s5, 0
    s_add_u32 s44, s42, 20480
    s_addc_u32 s45, s43, 0
    v_lshlrev_b32 v32, 3, v34
    v_lshl_add_u32 v32, v35, 9, v32
    s_lshl_b32 s32, s38, 11
    s_add_u32 s32, s32, 1114112
    s_barrier
    s_cmp_ge_u32 s31, 31
    s_cbranch_scc1 L_gu_idle_234079
    buffer_load_dwordx4 v[40:43], v30, s[4:7], s36 offen offset:0 sc1
    buffer_load_dwordx4 v[44:47], v30, s[4:7], s37 offen offset:0 sc1
    buffer_load_dwordx4 v[48:51], v30, s[4:7], s36 offen offset:1024 sc1
    buffer_load_dwordx4 v[52:55], v30, s[4:7], s37 offen offset:1024 sc1
    ds_read_b128 v[112:115], v31 offset:0
    ds_read_b128 v[116:119], v31 offset:1024
    ds_read_b128 v[120:123], v31 offset:2048
    ds_read_b128 v[124:127], v31 offset:3072
    ds_read_b128 v[128:131], v31 offset:4096
    ds_read_b128 v[132:135], v31 offset:5120
    ds_read_b128 v[136:139], v31 offset:6144
    buffer_load_dwordx4 v[56:59], v30, s[4:7], s36 offen offset:2048 sc1
    buffer_load_dwordx4 v[60:63], v30, s[4:7], s37 offen offset:2048 sc1
    s_setprio 3
    s_waitcnt vmcnt(4) lgkmcnt(0)
    v_mfma_f32_16x16x32_bf16 v[168:171], v[112:115], v[40:43], 0
    ds_read_b128 v[140:143], v31 offset:7168
    v_mfma_f32_16x16x32_bf16 v[172:175], v[112:115], v[44:47], 0
    v_mfma_f32_16x16x32_bf16 v[176:179], v[116:119], v[40:43], 0
    ds_read_b128 v[144:147], v31 offset:8192
    v_mfma_f32_16x16x32_bf16 v[180:183], v[116:119], v[44:47], 0
    v_mfma_f32_16x16x32_bf16 v[184:187], v[120:123], v[40:43], 0
    ds_read_b128 v[148:151], v31 offset:9216
    v_mfma_f32_16x16x32_bf16 v[188:191], v[120:123], v[44:47], 0
    v_mfma_f32_16x16x32_bf16 v[192:195], v[124:127], v[40:43], 0
    ds_read_b128 v[152:155], v31 offset:10240
    v_mfma_f32_16x16x32_bf16 v[196:199], v[124:127], v[44:47], 0
    buffer_load_dwordx4 v[64:67], v30, s[4:7], s36 offen offset:3072 sc1
    buffer_load_dwordx4 v[68:71], v30, s[4:7], s37 offen offset:3072 sc1
    s_add_u32 s36, s36, 4096
    s_add_u32 s37, s37, 4096
    buffer_load_dwordx4 v[72:75], v30, s[4:7], s36 offen offset:0 sc1
    buffer_load_dwordx4 v[76:79], v30, s[4:7], s37 offen offset:0 sc1
    v_mfma_f32_16x16x32_bf16 v[200:203], v[128:131], v[40:43], 0
    ds_read_b128 v[156:159], v31 offset:11264
    v_mfma_f32_16x16x32_bf16 v[204:207], v[128:131], v[44:47], 0
    v_mfma_f32_16x16x32_bf16 v[208:211], v[132:135], v[40:43], 0
    ds_read_b128 v[160:163], v31 offset:12288
    v_mfma_f32_16x16x32_bf16 v[212:215], v[132:135], v[44:47], 0
    v_mfma_f32_16x16x32_bf16 v[216:219], v[136:139], v[40:43], 0
    ds_read_b128 v[164:167], v31 offset:13312
    v_mfma_f32_16x16x32_bf16 v[220:223], v[136:139], v[44:47], 0
    s_waitcnt vmcnt(6) lgkmcnt(0)
    v_mfma_f32_16x16x32_bf16 v[168:171], v[140:143], v[48:51], v[168:171]
    ds_read_b128 v[112:115], v31 offset:14336
    v_mfma_f32_16x16x32_bf16 v[172:175], v[140:143], v[52:55], v[172:175]
    v_mfma_f32_16x16x32_bf16 v[176:179], v[144:147], v[48:51], v[176:179]
    ds_read_b128 v[116:119], v31 offset:15360
    v_mfma_f32_16x16x32_bf16 v[180:183], v[144:147], v[52:55], v[180:183]
    v_mfma_f32_16x16x32_bf16 v[184:187], v[148:151], v[48:51], v[184:187]
    ds_read_b128 v[120:123], v31 offset:16384
    v_mfma_f32_16x16x32_bf16 v[188:191], v[148:151], v[52:55], v[188:191]
    v_mfma_f32_16x16x32_bf16 v[192:195], v[152:155], v[48:51], v[192:195]
    ds_read_b128 v[124:127], v31 offset:17408
    v_mfma_f32_16x16x32_bf16 v[196:199], v[152:155], v[52:55], v[196:199]
    buffer_load_dwordx4 v[80:83], v30, s[4:7], s36 offen offset:1024 sc1
    buffer_load_dwordx4 v[84:87], v30, s[4:7], s37 offen offset:1024 sc1
    buffer_load_dwordx4 v[88:91], v30, s[4:7], s36 offen offset:2048 sc1
    buffer_load_dwordx4 v[92:95], v30, s[4:7], s37 offen offset:2048 sc1
    v_mfma_f32_16x16x32_bf16 v[200:203], v[156:159], v[48:51], v[200:203]
    ds_read_b128 v[128:131], v31 offset:18432
    v_mfma_f32_16x16x32_bf16 v[204:207], v[156:159], v[52:55], v[204:207]
    v_mfma_f32_16x16x32_bf16 v[208:211], v[160:163], v[48:51], v[208:211]
    ds_read_b128 v[132:135], v31 offset:19456
    v_mfma_f32_16x16x32_bf16 v[212:215], v[160:163], v[52:55], v[212:215]
    v_mfma_f32_16x16x32_bf16 v[216:219], v[164:167], v[48:51], v[216:219]
    ds_read_b128 v[136:139], v31 offset:20480
    v_mfma_f32_16x16x32_bf16 v[220:223], v[164:167], v[52:55], v[220:223]
    s_waitcnt vmcnt(8) lgkmcnt(0)
    v_mfma_f32_16x16x32_bf16 v[168:171], v[112:115], v[56:59], v[168:171]
    ds_read_b128 v[140:143], v31 offset:21504
    v_mfma_f32_16x16x32_bf16 v[172:175], v[112:115], v[60:63], v[172:175]
    v_mfma_f32_16x16x32_bf16 v[176:179], v[116:119], v[56:59], v[176:179]
    ds_read_b128 v[144:147], v31 offset:22528
    v_mfma_f32_16x16x32_bf16 v[180:183], v[116:119], v[60:63], v[180:183]
    v_mfma_f32_16x16x32_bf16 v[184:187], v[120:123], v[56:59], v[184:187]
    ds_read_b128 v[148:151], v31 offset:23552
    v_mfma_f32_16x16x32_bf16 v[188:191], v[120:123], v[60:63], v[188:191]
    v_mfma_f32_16x16x32_bf16 v[192:195], v[124:127], v[56:59], v[192:195]
    ds_read_b128 v[152:155], v31 offset:24576
    v_mfma_f32_16x16x32_bf16 v[196:199], v[124:127], v[60:63], v[196:199]
    buffer_load_dwordx4 v[96:99], v30, s[4:7], s36 offen offset:3072 sc1
    buffer_load_dwordx4 v[100:103], v30, s[4:7], s37 offen offset:3072 sc1
    s_add_u32 s36, s36, 4096
    s_add_u32 s37, s37, 4096
    buffer_load_dwordx4 v[104:107], v30, s[4:7], s36 offen offset:0 sc1
    buffer_load_dwordx4 v[108:111], v30, s[4:7], s37 offen offset:0 sc1
    v_mfma_f32_16x16x32_bf16 v[200:203], v[128:131], v[56:59], v[200:203]
    ds_read_b128 v[156:159], v31 offset:25600
    v_mfma_f32_16x16x32_bf16 v[204:207], v[128:131], v[60:63], v[204:207]
    v_mfma_f32_16x16x32_bf16 v[208:211], v[132:135], v[56:59], v[208:211]
    ds_read_b128 v[160:163], v31 offset:26624
    v_mfma_f32_16x16x32_bf16 v[212:215], v[132:135], v[60:63], v[212:215]
    v_mfma_f32_16x16x32_bf16 v[216:219], v[136:139], v[56:59], v[216:219]
    ds_read_b128 v[164:167], v31 offset:27648
    v_mfma_f32_16x16x32_bf16 v[220:223], v[136:139], v[60:63], v[220:223]
    s_waitcnt vmcnt(10) lgkmcnt(0)
    v_mfma_f32_16x16x32_bf16 v[168:171], v[140:143], v[64:67], v[168:171]
    ds_read_b128 v[112:115], v31 offset:28672
    v_mfma_f32_16x16x32_bf16 v[172:175], v[140:143], v[68:71], v[172:175]
    v_mfma_f32_16x16x32_bf16 v[176:179], v[144:147], v[64:67], v[176:179]
    ds_read_b128 v[116:119], v31 offset:29696
    v_mfma_f32_16x16x32_bf16 v[180:183], v[144:147], v[68:71], v[180:183]
    v_mfma_f32_16x16x32_bf16 v[184:187], v[148:151], v[64:67], v[184:187]
    ds_read_b128 v[120:123], v31 offset:30720
    v_mfma_f32_16x16x32_bf16 v[188:191], v[148:151], v[68:71], v[188:191]
    v_mfma_f32_16x16x32_bf16 v[192:195], v[152:155], v[64:67], v[192:195]
    ds_read_b128 v[124:127], v31 offset:31744
    v_mfma_f32_16x16x32_bf16 v[196:199], v[152:155], v[68:71], v[196:199]
    buffer_load_dwordx4 v[40:43], v30, s[4:7], s36 offen offset:1024 sc1
    buffer_load_dwordx4 v[44:47], v30, s[4:7], s37 offen offset:1024 sc1
    v_mfma_f32_16x16x32_bf16 v[200:203], v[156:159], v[64:67], v[200:203]
    ds_read_b128 v[128:131], v31 offset:32768
    v_mfma_f32_16x16x32_bf16 v[204:207], v[156:159], v[68:71], v[204:207]
    v_mfma_f32_16x16x32_bf16 v[208:211], v[160:163], v[64:67], v[208:211]
    ds_read_b128 v[132:135], v31 offset:33792
    v_mfma_f32_16x16x32_bf16 v[212:215], v[160:163], v[68:71], v[212:215]
    v_mfma_f32_16x16x32_bf16 v[216:219], v[164:167], v[64:67], v[216:219]
    ds_read_b128 v[136:139], v31 offset:34816
    v_mfma_f32_16x16x32_bf16 v[220:223], v[164:167], v[68:71], v[220:223]
    s_waitcnt vmcnt(10) lgkmcnt(0)
    v_mfma_f32_16x16x32_bf16 v[168:171], v[112:115], v[72:75], v[168:171]
    ds_read_b128 v[140:143], v31 offset:35840
    v_mfma_f32_16x16x32_bf16 v[172:175], v[112:115], v[76:79], v[172:175]
    v_mfma_f32_16x16x32_bf16 v[176:179], v[116:119], v[72:75], v[176:179]
    ds_read_b128 v[144:147], v31 offset:36864
    v_mfma_f32_16x16x32_bf16 v[180:183], v[116:119], v[76:79], v[180:183]
    v_mfma_f32_16x16x32_bf16 v[184:187], v[120:123], v[72:75], v[184:187]
    ds_read_b128 v[148:151], v31 offset:37888
    v_mfma_f32_16x16x32_bf16 v[188:191], v[120:123], v[76:79], v[188:191]
    v_mfma_f32_16x16x32_bf16 v[192:195], v[124:127], v[72:75], v[192:195]
    ds_read_b128 v[152:155], v31 offset:38912
    v_mfma_f32_16x16x32_bf16 v[196:199], v[124:127], v[76:79], v[196:199]
    buffer_load_dwordx4 v[48:51], v30, s[4:7], s36 offen offset:2048 sc1
    buffer_load_dwordx4 v[52:55], v30, s[4:7], s37 offen offset:2048 sc1
    v_mfma_f32_16x16x32_bf16 v[200:203], v[128:131], v[72:75], v[200:203]
    ds_read_b128 v[156:159], v31 offset:39936
    v_mfma_f32_16x16x32_bf16 v[204:207], v[128:131], v[76:79], v[204:207]
    v_mfma_f32_16x16x32_bf16 v[208:211], v[132:135], v[72:75], v[208:211]
    ds_read_b128 v[160:163], v31 offset:40960
    v_mfma_f32_16x16x32_bf16 v[212:215], v[132:135], v[76:79], v[212:215]
    v_mfma_f32_16x16x32_bf16 v[216:219], v[136:139], v[72:75], v[216:219]
    ds_read_b128 v[164:167], v31 offset:41984
    v_mfma_f32_16x16x32_bf16 v[220:223], v[136:139], v[76:79], v[220:223]
    s_setprio 2
    s_waitcnt vmcnt(10) lgkmcnt(0)
    v_mfma_f32_16x16x32_bf16 v[168:171], v[140:143], v[80:83], v[168:171]
    ds_read_b128 v[112:115], v31 offset:43008
    v_mfma_f32_16x16x32_bf16 v[172:175], v[140:143], v[84:87], v[172:175]
    v_mfma_f32_16x16x32_bf16 v[176:179], v[144:147], v[80:83], v[176:179]
    ds_read_b128 v[116:119], v31 offset:44032
    v_mfma_f32_16x16x32_bf16 v[180:183], v[144:147], v[84:87], v[180:183]
    v_mfma_f32_16x16x32_bf16 v[184:187], v[148:151], v[80:83], v[184:187]
    ds_read_b128 v[120:123], v31 offset:45056
    v_mfma_f32_16x16x32_bf16 v[188:191], v[148:151], v[84:87], v[188:191]
    v_mfma_f32_16x16x32_bf16 v[192:195], v[152:155], v[80:83], v[192:195]
    ds_read_b128 v[124:127], v31 offset:46080
    v_mfma_f32_16x16x32_bf16 v[196:199], v[152:155], v[84:87], v[196:199]
    buffer_load_dwordx4 v[56:59], v30, s[4:7], s36 offen offset:3072 sc1
    buffer_load_dwordx4 v[60:63], v30, s[4:7], s37 offen offset:3072 sc1
    s_add_u32 s36, s36, 4096
    s_add_u32 s37, s37, 4096
    v_mfma_f32_16x16x32_bf16 v[200:203], v[156:159], v[80:83], v[200:203]
    ds_read_b128 v[128:131], v31 offset:47104
    v_mfma_f32_16x16x32_bf16 v[204:207], v[156:159], v[84:87], v[204:207]
    v_mfma_f32_16x16x32_bf16 v[208:211], v[160:163], v[80:83], v[208:211]
    ds_read_b128 v[132:135], v31 offset:48128
    v_mfma_f32_16x16x32_bf16 v[212:215], v[160:163], v[84:87], v[212:215]
    v_mfma_f32_16x16x32_bf16 v[216:219], v[164:167], v[80:83], v[216:219]
    ds_read_b128 v[136:139], v31 offset:49152
    v_mfma_f32_16x16x32_bf16 v[220:223], v[164:167], v[84:87], v[220:223]
    s_waitcnt vmcnt(10) lgkmcnt(0)
    v_mfma_f32_16x16x32_bf16 v[168:171], v[112:115], v[88:91], v[168:171]
    ds_read_b128 v[140:143], v31 offset:50176
    v_mfma_f32_16x16x32_bf16 v[172:175], v[112:115], v[92:95], v[172:175]
    v_mfma_f32_16x16x32_bf16 v[176:179], v[116:119], v[88:91], v[176:179]
    ds_read_b128 v[144:147], v31 offset:51200
    v_mfma_f32_16x16x32_bf16 v[180:183], v[116:119], v[92:95], v[180:183]
    v_mfma_f32_16x16x32_bf16 v[184:187], v[120:123], v[88:91], v[184:187]
    ds_read_b128 v[148:151], v31 offset:52224
    v_mfma_f32_16x16x32_bf16 v[188:191], v[120:123], v[92:95], v[188:191]
    v_mfma_f32_16x16x32_bf16 v[192:195], v[124:127], v[88:91], v[192:195]
    ds_read_b128 v[152:155], v31 offset:53248
    v_mfma_f32_16x16x32_bf16 v[196:199], v[124:127], v[92:95], v[196:199]
    buffer_load_dwordx4 v[64:67], v30, s[4:7], s36 offen offset:0 sc1
    buffer_load_dwordx4 v[68:71], v30, s[4:7], s37 offen offset:0 sc1
    v_mfma_f32_16x16x32_bf16 v[200:203], v[128:131], v[88:91], v[200:203]
    ds_read_b128 v[156:159], v31 offset:54272
    v_mfma_f32_16x16x32_bf16 v[204:207], v[128:131], v[92:95], v[204:207]
    v_mfma_f32_16x16x32_bf16 v[208:211], v[132:135], v[88:91], v[208:211]
    ds_read_b128 v[160:163], v31 offset:55296
    v_mfma_f32_16x16x32_bf16 v[212:215], v[132:135], v[92:95], v[212:215]
    v_mfma_f32_16x16x32_bf16 v[216:219], v[136:139], v[88:91], v[216:219]
    ds_read_b128 v[164:167], v31 offset:56320
    v_mfma_f32_16x16x32_bf16 v[220:223], v[136:139], v[92:95], v[220:223]
    buffer_load_dwordx2 v[224:225], v32, s[4:7], s32 offen offset:0 sc1
    buffer_load_dwordx2 v[226:227], v32, s[4:7], s32 offen offset:128 sc1
    buffer_load_dwordx2 v[228:229], v32, s[4:7], s32 offen offset:256 sc1
    buffer_load_dwordx2 v[230:231], v32, s[4:7], s32 offen offset:384 sc1
    buffer_load_dwordx2 v[232:233], v32, s[4:7], s32 offen offset:2048 sc1
    buffer_load_dwordx2 v[234:235], v32, s[4:7], s32 offen offset:2176 sc1
    buffer_load_dwordx2 v[236:237], v32, s[4:7], s32 offen offset:2304 sc1
    buffer_load_dwordx2 v[238:239], v32, s[4:7], s32 offen offset:2432 sc1
    v_add_u32 v31, 57344, v31
    s_waitcnt vmcnt(18) lgkmcnt(0)
    v_mfma_f32_16x16x32_bf16 v[168:171], v[140:143], v[96:99], v[168:171]
    ds_read_b128 v[112:115], v31 offset:0
    v_mfma_f32_16x16x32_bf16 v[172:175], v[140:143], v[100:103], v[172:175]
    v_mfma_f32_16x16x32_bf16 v[176:179], v[144:147], v[96:99], v[176:179]
    ds_read_b128 v[116:119], v31 offset:1024
    v_mfma_f32_16x16x32_bf16 v[180:183], v[144:147], v[100:103], v[180:183]
    v_mfma_f32_16x16x32_bf16 v[184:187], v[148:151], v[96:99], v[184:187]
    ds_read_b128 v[120:123], v31 offset:2048
    v_mfma_f32_16x16x32_bf16 v[188:191], v[148:151], v[100:103], v[188:191]
    v_mfma_f32_16x16x32_bf16 v[192:195], v[152:155], v[96:99], v[192:195]
    ds_read_b128 v[124:127], v31 offset:3072
    v_mfma_f32_16x16x32_bf16 v[196:199], v[152:155], v[100:103], v[196:199]
    buffer_load_dwordx4 v[72:75], v30, s[4:7], s36 offen offset:1024 sc1
    buffer_load_dwordx4 v[76:79], v30, s[4:7], s37 offen offset:1024 sc1
    v_mfma_f32_16x16x32_bf16 v[200:203], v[156:159], v[96:99], v[200:203]
    ds_read_b128 v[128:131], v31 offset:4096
    v_mfma_f32_16x16x32_bf16 v[204:207], v[156:159], v[100:103], v[204:207]
    v_mfma_f32_16x16x32_bf16 v[208:211], v[160:163], v[96:99], v[208:211]
    ds_read_b128 v[132:135], v31 offset:5120
    v_mfma_f32_16x16x32_bf16 v[212:215], v[160:163], v[100:103], v[212:215]
    v_mfma_f32_16x16x32_bf16 v[216:219], v[164:167], v[96:99], v[216:219]
    ds_read_b128 v[136:139], v31 offset:6144
    v_mfma_f32_16x16x32_bf16 v[220:223], v[164:167], v[100:103], v[220:223]
    s_waitcnt vmcnt(18) lgkmcnt(0)
    v_mfma_f32_16x16x32_bf16 v[168:171], v[112:115], v[104:107], v[168:171]
    ds_read_b128 v[140:143], v31 offset:7168
    v_mfma_f32_16x16x32_bf16 v[172:175], v[112:115], v[108:111], v[172:175]
    v_mfma_f32_16x16x32_bf16 v[176:179], v[116:119], v[104:107], v[176:179]
    ds_read_b128 v[144:147], v31 offset:8192
    v_mfma_f32_16x16x32_bf16 v[180:183], v[116:119], v[108:111], v[180:183]
    v_mfma_f32_16x16x32_bf16 v[184:187], v[120:123], v[104:107], v[184:187]
    ds_read_b128 v[148:151], v31 offset:9216
    v_mfma_f32_16x16x32_bf16 v[188:191], v[120:123], v[108:111], v[188:191]
    v_mfma_f32_16x16x32_bf16 v[192:195], v[124:127], v[104:107], v[192:195]
    ds_read_b128 v[152:155], v31 offset:10240
    v_mfma_f32_16x16x32_bf16 v[196:199], v[124:127], v[108:111], v[196:199]
    buffer_load_dwordx4 v[80:83], v30, s[4:7], s36 offen offset:2048 sc1
    buffer_load_dwordx4 v[84:87], v30, s[4:7], s37 offen offset:2048 sc1
    v_mfma_f32_16x16x32_bf16 v[200:203], v[128:131], v[104:107], v[200:203]
    ds_read_b128 v[156:159], v31 offset:11264
    v_mfma_f32_16x16x32_bf16 v[204:207], v[128:131], v[108:111], v[204:207]
    v_mfma_f32_16x16x32_bf16 v[208:211], v[132:135], v[104:107], v[208:211]
    ds_read_b128 v[160:163], v31 offset:12288
    v_mfma_f32_16x16x32_bf16 v[212:215], v[132:135], v[108:111], v[212:215]
    v_mfma_f32_16x16x32_bf16 v[216:219], v[136:139], v[104:107], v[216:219]
    ds_read_b128 v[164:167], v31 offset:13312
    v_mfma_f32_16x16x32_bf16 v[220:223], v[136:139], v[108:111], v[220:223]
    s_waitcnt vmcnt(18) lgkmcnt(0)
    v_mfma_f32_16x16x32_bf16 v[168:171], v[140:143], v[40:43], v[168:171]
    ds_read_b128 v[112:115], v31 offset:14336
    v_mfma_f32_16x16x32_bf16 v[172:175], v[140:143], v[44:47], v[172:175]
    v_mfma_f32_16x16x32_bf16 v[176:179], v[144:147], v[40:43], v[176:179]
    ds_read_b128 v[116:119], v31 offset:15360
    v_mfma_f32_16x16x32_bf16 v[180:183], v[144:147], v[44:47], v[180:183]
    v_mfma_f32_16x16x32_bf16 v[184:187], v[148:151], v[40:43], v[184:187]
    ds_read_b128 v[120:123], v31 offset:16384
    v_mfma_f32_16x16x32_bf16 v[188:191], v[148:151], v[44:47], v[188:191]
    v_mfma_f32_16x16x32_bf16 v[192:195], v[152:155], v[40:43], v[192:195]
    ds_read_b128 v[124:127], v31 offset:17408
    v_mfma_f32_16x16x32_bf16 v[196:199], v[152:155], v[44:47], v[196:199]
    buffer_load_dwordx4 v[88:91], v30, s[4:7], s36 offen offset:3072 sc1
    buffer_load_dwordx4 v[92:95], v30, s[4:7], s37 offen offset:3072 sc1
    s_add_u32 s36, s36, 4096
    s_add_u32 s37, s37, 4096
    v_mfma_f32_16x16x32_bf16 v[200:203], v[156:159], v[40:43], v[200:203]
    ds_read_b128 v[128:131], v31 offset:18432
    v_mfma_f32_16x16x32_bf16 v[204:207], v[156:159], v[44:47], v[204:207]
    v_mfma_f32_16x16x32_bf16 v[208:211], v[160:163], v[40:43], v[208:211]
    ds_read_b128 v[132:135], v31 offset:19456
    v_mfma_f32_16x16x32_bf16 v[212:215], v[160:163], v[44:47], v[212:215]
    v_mfma_f32_16x16x32_bf16 v[216:219], v[164:167], v[40:43], v[216:219]
    ds_read_b128 v[136:139], v31 offset:20480
    v_mfma_f32_16x16x32_bf16 v[220:223], v[164:167], v[44:47], v[220:223]
    s_setprio 1
    s_waitcnt vmcnt(18) lgkmcnt(0)
    v_mfma_f32_16x16x32_bf16 v[168:171], v[112:115], v[48:51], v[168:171]
    ds_read_b128 v[140:143], v31 offset:21504
    v_mfma_f32_16x16x32_bf16 v[172:175], v[112:115], v[52:55], v[172:175]
    v_mfma_f32_16x16x32_bf16 v[176:179], v[116:119], v[48:51], v[176:179]
    ds_read_b128 v[144:147], v31 offset:22528
    v_mfma_f32_16x16x32_bf16 v[180:183], v[116:119], v[52:55], v[180:183]
    v_mfma_f32_16x16x32_bf16 v[184:187], v[120:123], v[48:51], v[184:187]
    ds_read_b128 v[148:151], v31 offset:23552
    v_mfma_f32_16x16x32_bf16 v[188:191], v[120:123], v[52:55], v[188:191]
    v_mfma_f32_16x16x32_bf16 v[192:195], v[124:127], v[48:51], v[192:195]
    ds_read_b128 v[152:155], v31 offset:24576
    v_mfma_f32_16x16x32_bf16 v[196:199], v[124:127], v[52:55], v[196:199]
    buffer_load_dwordx4 v[96:99], v30, s[4:7], s36 offen offset:0 sc1
    buffer_load_dwordx4 v[100:103], v30, s[4:7], s37 offen offset:0 sc1
    v_mfma_f32_16x16x32_bf16 v[200:203], v[128:131], v[48:51], v[200:203]
    ds_read_b128 v[156:159], v31 offset:25600
    v_mfma_f32_16x16x32_bf16 v[204:207], v[128:131], v[52:55], v[204:207]
    v_mfma_f32_16x16x32_bf16 v[208:211], v[132:135], v[48:51], v[208:211]
    ds_read_b128 v[160:163], v31 offset:26624
    v_mfma_f32_16x16x32_bf16 v[212:215], v[132:135], v[52:55], v[212:215]
    v_mfma_f32_16x16x32_bf16 v[216:219], v[136:139], v[48:51], v[216:219]
    ds_read_b128 v[164:167], v31 offset:27648
    v_mfma_f32_16x16x32_bf16 v[220:223], v[136:139], v[52:55], v[220:223]
    v_lshlrev_b32 v29, 4, v1
    s_bfe_u32 s29, s2, 0x20001
    s_lshl_b32 s29, s29, 3
    s_lshr_b32 s26, s2, 5
    s_add_u32 s29, s29, s26
    s_and_b32 s28, s2, 1
    s_lshl_b32 s28, s28, 2
    s_bfe_u32 s26, s2, 0x20003
    s_add_u32 s28, s28, s26
    s_mul_i32 s28, s28, 276480
    s_add_u32 s28, s28, 24969216
    s_add_u32 s29, s10, 0
    s_lshl_b32 s29, s29, 10
    s_add_u32 s26, s28, s29
    s_add_u32 s27, s29, 0
    s_mov_b32 m0, s27
    s_add_u32 s27, s27, 8192
    buffer_load_dwordx4 v29, s[4:7], s26 offen sc1 lds
    s_add_u32 s26, s26, 8192
    s_mov_b32 m0, s27
    s_add_u32 s27, s27, 8192
    buffer_load_dwordx4 v29, s[4:7], s26 offen sc1 lds
    s_add_u32 s26, s26, 8192
    s_waitcnt vmcnt(20) lgkmcnt(0)
    v_mfma_f32_16x16x32_bf16 v[168:171], v[140:143], v[56:59], v[168:171]
    ds_read_b128 v[112:115], v31 offset:28672
    v_mfma_f32_16x16x32_bf16 v[172:175], v[140:143], v[60:63], v[172:175]
    v_mfma_f32_16x16x32_bf16 v[176:179], v[144:147], v[56:59], v[176:179]
    ds_read_b128 v[116:119], v31 offset:29696
    v_mfma_f32_16x16x32_bf16 v[180:183], v[144:147], v[60:63], v[180:183]
    v_mfma_f32_16x16x32_bf16 v[184:187], v[148:151], v[56:59], v[184:187]
    ds_read_b128 v[120:123], v31 offset:30720
    v_mfma_f32_16x16x32_bf16 v[188:191], v[148:151], v[60:63], v[188:191]
    v_mfma_f32_16x16x32_bf16 v[192:195], v[152:155], v[56:59], v[192:195]
    ds_read_b128 v[124:127], v31 offset:31744
    v_mfma_f32_16x16x32_bf16 v[196:199], v[152:155], v[60:63], v[196:199]
    buffer_load_dwordx4 v[104:107], v30, s[4:7], s36 offen offset:1024 sc1
    buffer_load_dwordx4 v[108:111], v30, s[4:7], s37 offen offset:1024 sc1
    v_mfma_f32_16x16x32_bf16 v[200:203], v[156:159], v[56:59], v[200:203]
    ds_read_b128 v[128:131], v31 offset:32768
    v_mfma_f32_16x16x32_bf16 v[204:207], v[156:159], v[60:63], v[204:207]
    v_mfma_f32_16x16x32_bf16 v[208:211], v[160:163], v[56:59], v[208:211]
    ds_read_b128 v[132:135], v31 offset:33792
    v_mfma_f32_16x16x32_bf16 v[212:215], v[160:163], v[60:63], v[212:215]
    v_mfma_f32_16x16x32_bf16 v[216:219], v[164:167], v[56:59], v[216:219]
    ds_read_b128 v[136:139], v31 offset:34816
    v_mfma_f32_16x16x32_bf16 v[220:223], v[164:167], v[60:63], v[220:223]
    s_waitcnt vmcnt(20) lgkmcnt(0)
    v_mfma_f32_16x16x32_bf16 v[168:171], v[112:115], v[64:67], v[168:171]
    ds_read_b128 v[140:143], v31 offset:35840
    v_mfma_f32_16x16x32_bf16 v[172:175], v[112:115], v[68:71], v[172:175]
    v_mfma_f32_16x16x32_bf16 v[176:179], v[116:119], v[64:67], v[176:179]
    ds_read_b128 v[144:147], v31 offset:36864
    v_mfma_f32_16x16x32_bf16 v[180:183], v[116:119], v[68:71], v[180:183]
    v_mfma_f32_16x16x32_bf16 v[184:187], v[120:123], v[64:67], v[184:187]
    ds_read_b128 v[148:151], v31 offset:37888
    v_mfma_f32_16x16x32_bf16 v[188:191], v[120:123], v[68:71], v[188:191]
    v_mfma_f32_16x16x32_bf16 v[192:195], v[124:127], v[64:67], v[192:195]
    ds_read_b128 v[152:155], v31 offset:38912
    v_mfma_f32_16x16x32_bf16 v[196:199], v[124:127], v[68:71], v[196:199]
    buffer_load_dwordx4 v[40:43], v30, s[4:7], s36 offen offset:2048 sc1
    buffer_load_dwordx4 v[44:47], v30, s[4:7], s37 offen offset:2048 sc1
    v_mfma_f32_16x16x32_bf16 v[200:203], v[128:131], v[64:67], v[200:203]
    ds_read_b128 v[156:159], v31 offset:39936
    v_mfma_f32_16x16x32_bf16 v[204:207], v[128:131], v[68:71], v[204:207]
    v_mfma_f32_16x16x32_bf16 v[208:211], v[132:135], v[64:67], v[208:211]
    ds_read_b128 v[160:163], v31 offset:40960
    v_mfma_f32_16x16x32_bf16 v[212:215], v[132:135], v[68:71], v[212:215]
    v_mfma_f32_16x16x32_bf16 v[216:219], v[136:139], v[64:67], v[216:219]
    ds_read_b128 v[164:167], v31 offset:41984
    v_mfma_f32_16x16x32_bf16 v[220:223], v[136:139], v[68:71], v[220:223]
    s_waitcnt vmcnt(14)
    v_add_f32 v224, v224, v226
    v_add_f32 v225, v225, v227
    v_add_f32 v228, v228, v230
    v_add_f32 v229, v229, v231
    v_add_f32 v224, v224, v228
    v_add_f32 v225, v225, v229
    v_mov_b32 v226, v224
    v_mov_b32 v227, v225
    s_nop 1
    v_permlane32_swap_b32 v224, v226
    v_permlane32_swap_b32 v225, v227
    s_nop 0
    v_add_f32 v224, v224, v226
    v_add_f32 v225, v225, v227
    v_mov_b32 v226, v224
    v_mov_b32 v227, v225
    s_nop 1
    v_permlane16_swap_b32 v224, v226
    v_permlane16_swap_b32 v225, v227
    s_nop 0
    v_add_f32 v224, v224, v226
    v_add_f32 v225, v225, v227
    v_mul_f32 v224, 0xbacccccd, v224
    v_mul_f32 v225, 0x3acccccd, v225
    v_fma_f32 v225, -v224, v224, v225
    v_max_f32 v225, 0, v225
    v_add_f32 v225, 0x3727c5ac, v225
    v_sqrt_f32 v248, v225
    v_rsq_f32 v249, v225
    v_cvt_pk_bf16_f32 v226, v224, v224
    v_cvt_pk_bf16_f32 v227, v248, v248
    v_mul_f32 v249, 0xbfb8aa3b, v249
    v_and_b32 v226, 0xffff0000, v226
    v_and_b32 v227, 0xffff0000, v227
    v_sub_f32 v228, v224, v226
    v_sub_f32 v229, v248, v227
    v_cmp_gt_u32 vcc, 16, v1
    v_cvt_pk_bf16_f32 v240, v226, v228
    v_cvt_pk_bf16_f32 v241, v226, v227
    v_cvt_pk_bf16_f32 v242, v229, v227
    v_mov_b32 v243, 0
    v_cndmask_b32 v240, 0, v240, vcc
    v_cndmask_b32 v241, 0, v241, vcc
    v_cndmask_b32 v242, 0, v242, vcc
    v_add_f32 v232, v232, v234
    v_add_f32 v233, v233, v235
    v_add_f32 v236, v236, v238
    v_add_f32 v237, v237, v239
    v_add_f32 v232, v232, v236
    v_add_f32 v233, v233, v237
    v_mov_b32 v234, v232
    v_mov_b32 v235, v233
    s_nop 1
    v_permlane32_swap_b32 v232, v234
    v_permlane32_swap_b32 v233, v235
    s_nop 0
    v_add_f32 v232, v232, v234
    v_add_f32 v233, v233, v235
    v_mov_b32 v234, v232
    v_mov_b32 v235, v233
    s_nop 1
    v_permlane16_swap_b32 v232, v234
    v_permlane16_swap_b32 v233, v235
    s_nop 0
    v_add_f32 v232, v232, v234
    v_add_f32 v233, v233, v235
    v_mul_f32 v232, 0xbacccccd, v232
    v_mul_f32 v233, 0x3acccccd, v233
    v_fma_f32 v233, -v232, v232, v233
    v_max_f32 v233, 0, v233
    v_add_f32 v233, 0x3727c5ac, v233
    v_sqrt_f32 v250, v233
    v_rsq_f32 v251, v233
    v_cvt_pk_bf16_f32 v234, v232, v232
    v_cvt_pk_bf16_f32 v235, v250, v250
    v_mul_f32 v251, 0xbfb8aa3b, v251
    v_and_b32 v234, 0xffff0000, v234
    v_and_b32 v235, 0xffff0000, v235
    v_sub_f32 v236, v232, v234
    v_sub_f32 v237, v250, v235
    v_cmp_gt_u32 vcc, 16, v1
    v_cvt_pk_bf16_f32 v244, v234, v236
    v_cvt_pk_bf16_f32 v245, v234, v235
    v_cvt_pk_bf16_f32 v246, v237, v235
    v_mov_b32 v247, 0
    v_cndmask_b32 v244, 0, v244, vcc
    v_cndmask_b32 v245, 0, v245, vcc
    v_cndmask_b32 v246, 0, v246, vcc
    s_waitcnt vmcnt(12) lgkmcnt(0)
    v_mfma_f32_16x16x32_bf16 v[168:171], v[140:143], v[72:75], v[168:171]
    ds_read_b128 v[112:115], v31 offset:43008
    v_mfma_f32_16x16x32_bf16 v[172:175], v[140:143], v[76:79], v[172:175]
    v_mfma_f32_16x16x32_bf16 v[176:179], v[144:147], v[72:75], v[176:179]
    ds_read_b128 v[116:119], v31 offset:44032
    v_mfma_f32_16x16x32_bf16 v[180:183], v[144:147], v[76:79], v[180:183]
    v_mfma_f32_16x16x32_bf16 v[184:187], v[148:151], v[72:75], v[184:187]
    ds_read_b128 v[120:123], v31 offset:45056
    v_mfma_f32_16x16x32_bf16 v[188:191], v[148:151], v[76:79], v[188:191]
    v_mfma_f32_16x16x32_bf16 v[192:195], v[152:155], v[72:75], v[192:195]
    ds_read_b128 v[124:127], v31 offset:46080
    v_mfma_f32_16x16x32_bf16 v[196:199], v[152:155], v[76:79], v[196:199]
    buffer_load_dwordx4 v[48:51], v30, s[4:7], s36 offen offset:3072 sc1
    buffer_load_dwordx4 v[52:55], v30, s[4:7], s37 offen offset:3072 sc1
    s_add_u32 s36, s36, 4096
    s_add_u32 s37, s37, 4096
    v_mfma_f32_16x16x32_bf16 v[200:203], v[156:159], v[72:75], v[200:203]
    ds_read_b128 v[128:131], v31 offset:47104
    v_mfma_f32_16x16x32_bf16 v[204:207], v[156:159], v[76:79], v[204:207]
    v_mfma_f32_16x16x32_bf16 v[208:211], v[160:163], v[72:75], v[208:211]
    ds_read_b128 v[132:135], v31 offset:48128
    v_mfma_f32_16x16x32_bf16 v[212:215], v[160:163], v[76:79], v[212:215]
    v_mfma_f32_16x16x32_bf16 v[216:219], v[164:167], v[72:75], v[216:219]
    ds_read_b128 v[136:139], v31 offset:49152
    v_mfma_f32_16x16x32_bf16 v[220:223], v[164:167], v[76:79], v[220:223]
    s_waitcnt vmcnt(12) lgkmcnt(0)
    v_mfma_f32_16x16x32_bf16 v[168:171], v[112:115], v[80:83], v[168:171]
    ds_read_b128 v[140:143], v31 offset:50176
    v_mfma_f32_16x16x32_bf16 v[172:175], v[112:115], v[84:87], v[172:175]
    v_mfma_f32_16x16x32_bf16 v[176:179], v[116:119], v[80:83], v[176:179]
    ds_read_b128 v[144:147], v31 offset:51200
    v_mfma_f32_16x16x32_bf16 v[180:183], v[116:119], v[84:87], v[180:183]
    v_mfma_f32_16x16x32_bf16 v[184:187], v[120:123], v[80:83], v[184:187]
    ds_read_b128 v[148:151], v31 offset:52224
    v_mfma_f32_16x16x32_bf16 v[188:191], v[120:123], v[84:87], v[188:191]
    v_mfma_f32_16x16x32_bf16 v[192:195], v[124:127], v[80:83], v[192:195]
    ds_read_b128 v[152:155], v31 offset:53248
    v_mfma_f32_16x16x32_bf16 v[196:199], v[124:127], v[84:87], v[196:199]
    v_mfma_f32_16x16x32_bf16 v[200:203], v[128:131], v[80:83], v[200:203]
    ds_read_b128 v[156:159], v31 offset:54272
    v_mfma_f32_16x16x32_bf16 v[204:207], v[128:131], v[84:87], v[204:207]
    v_mfma_f32_16x16x32_bf16 v[208:211], v[132:135], v[80:83], v[208:211]
    ds_read_b128 v[160:163], v31 offset:55296
    v_mfma_f32_16x16x32_bf16 v[212:215], v[132:135], v[84:87], v[212:215]
    v_mfma_f32_16x16x32_bf16 v[216:219], v[136:139], v[80:83], v[216:219]
    ds_read_b128 v[164:167], v31 offset:56320
    v_mfma_f32_16x16x32_bf16 v[220:223], v[136:139], v[84:87], v[220:223]
    s_setprio 0
    v_add_u32 v31, 57344, v31
    s_waitcnt vmcnt(10) lgkmcnt(0)
    v_mfma_f32_16x16x32_bf16 v[168:171], v[140:143], v[88:91], v[168:171]
    ds_read_b128 v[112:115], v31 offset:0
    v_mfma_f32_16x16x32_bf16 v[172:175], v[140:143], v[92:95], v[172:175]
    v_mfma_f32_16x16x32_bf16 v[176:179], v[144:147], v[88:91], v[176:179]
    ds_read_b128 v[116:119], v31 offset:1024
    v_mfma_f32_16x16x32_bf16 v[180:183], v[144:147], v[92:95], v[180:183]
    v_mfma_f32_16x16x32_bf16 v[184:187], v[148:151], v[88:91], v[184:187]
    ds_read_b128 v[120:123], v31 offset:2048
    v_mfma_f32_16x16x32_bf16 v[188:191], v[148:151], v[92:95], v[188:191]
    v_mfma_f32_16x16x32_bf16 v[192:195], v[152:155], v[88:91], v[192:195]
    ds_read_b128 v[124:127], v31 offset:3072
    v_mfma_f32_16x16x32_bf16 v[196:199], v[152:155], v[92:95], v[196:199]
    v_mfma_f32_16x16x32_bf16 v[200:203], v[156:159], v[88:91], v[200:203]
    ds_read_b128 v[128:131], v31 offset:4096
    v_mfma_f32_16x16x32_bf16 v[204:207], v[156:159], v[92:95], v[204:207]
    v_mfma_f32_16x16x32_bf16 v[208:211], v[160:163], v[88:91], v[208:211]
    ds_read_b128 v[132:135], v31 offset:5120
    v_mfma_f32_16x16x32_bf16 v[212:215], v[160:163], v[92:95], v[212:215]
    v_mfma_f32_16x16x32_bf16 v[216:219], v[164:167], v[88:91], v[216:219]
    ds_read_b128 v[136:139], v31 offset:6144
    v_mfma_f32_16x16x32_bf16 v[220:223], v[164:167], v[92:95], v[220:223]
    v_min_u32 v32, 1, v35
    v_lshlrev_b32 v32, 30, v32
    v_lshl_add_u32 v32, v34, 4, v32
    s_mul_i32 s32, s31, 1792
    s_add_u32 s32, s32, 851968
    buffer_load_dwordx4 v[56:59], v32, s[4:7], s32 offen offset:0 sc1
    buffer_load_dwordx4 v[60:63], v32, s[4:7], s32 offen offset:256 sc1
    buffer_load_dwordx4 v[64:67], v32, s[4:7], s32 offen offset:512 sc1
    buffer_load_dwordx4 v[68:71], v32, s[4:7], s32 offen offset:768 sc1
    buffer_load_dwordx4 v[72:75], v32, s[4:7], s32 offen offset:1024 sc1
    buffer_load_dwordx4 v[76:79], v32, s[4:7], s32 offen offset:1280 sc1
    buffer_load_dwordx4 v[80:83], v32, s[4:7], s32 offen offset:1536 sc1
    s_waitcnt vmcnt(15) lgkmcnt(0)
    v_mfma_f32_16x16x32_bf16 v[168:171], v[112:115], v[96:99], v[168:171]
    ds_read_b128 v[140:143], v31 offset:7168
    v_mfma_f32_16x16x32_bf16 v[172:175], v[112:115], v[100:103], v[172:175]
    v_mfma_f32_16x16x32_bf16 v[176:179], v[116:119], v[96:99], v[176:179]
    ds_read_b128 v[144:147], v31 offset:8192
    v_mfma_f32_16x16x32_bf16 v[180:183], v[116:119], v[100:103], v[180:183]
    v_mfma_f32_16x16x32_bf16 v[184:187], v[120:123], v[96:99], v[184:187]
    ds_read_b128 v[148:151], v31 offset:9216
    v_mfma_f32_16x16x32_bf16 v[188:191], v[120:123], v[100:103], v[188:191]
    v_mfma_f32_16x16x32_bf16 v[192:195], v[124:127], v[96:99], v[192:195]
    ds_read_b128 v[152:155], v31 offset:10240
    v_mfma_f32_16x16x32_bf16 v[196:199], v[124:127], v[100:103], v[196:199]
    v_mfma_f32_16x16x32_bf16 v[200:203], v[128:131], v[96:99], v[200:203]
    ds_read_b128 v[156:159], v31 offset:11264
    v_mfma_f32_16x16x32_bf16 v[204:207], v[128:131], v[100:103], v[204:207]
    v_mfma_f32_16x16x32_bf16 v[208:211], v[132:135], v[96:99], v[208:211]
    ds_read_b128 v[160:163], v31 offset:12288
    v_mfma_f32_16x16x32_bf16 v[212:215], v[132:135], v[100:103], v[212:215]
    v_mfma_f32_16x16x32_bf16 v[216:219], v[136:139], v[96:99], v[216:219]
    ds_read_b128 v[164:167], v31 offset:13312
    v_mfma_f32_16x16x32_bf16 v[220:223], v[136:139], v[100:103], v[220:223]
    s_waitcnt vmcnt(11) lgkmcnt(0)
    v_mfma_f32_16x16x32_bf16 v[168:171], v[140:143], v[104:107], v[168:171]
    ds_read_b128 v[112:115], v31 offset:14336
    v_mfma_f32_16x16x32_bf16 v[172:175], v[140:143], v[108:111], v[172:175]
    v_mfma_f32_16x16x32_bf16 v[176:179], v[144:147], v[104:107], v[176:179]
    ds_read_b128 v[116:119], v31 offset:15360
    v_mfma_f32_16x16x32_bf16 v[180:183], v[144:147], v[108:111], v[180:183]
    v_mfma_f32_16x16x32_bf16 v[184:187], v[148:151], v[104:107], v[184:187]
    ds_read_b128 v[120:123], v31 offset:16384
    v_mfma_f32_16x16x32_bf16 v[188:191], v[148:151], v[108:111], v[188:191]
    v_mfma_f32_16x16x32_bf16 v[192:195], v[152:155], v[104:107], v[192:195]
    ds_read_b128 v[124:127], v31 offset:17408
    v_mfma_f32_16x16x32_bf16 v[196:199], v[152:155], v[108:111], v[196:199]
    v_mfma_f32_16x16x32_bf16 v[200:203], v[156:159], v[104:107], v[200:203]
    ds_read_b128 v[128:131], v31 offset:18432
    v_mfma_f32_16x16x32_bf16 v[204:207], v[156:159], v[108:111], v[204:207]
    v_mfma_f32_16x16x32_bf16 v[208:211], v[160:163], v[104:107], v[208:211]
    ds_read_b128 v[132:135], v31 offset:19456
    v_mfma_f32_16x16x32_bf16 v[212:215], v[160:163], v[108:111], v[212:215]
    v_mfma_f32_16x16x32_bf16 v[216:219], v[164:167], v[104:107], v[216:219]
    ds_read_b128 v[136:139], v31 offset:20480
    v_mfma_f32_16x16x32_bf16 v[220:223], v[164:167], v[108:111], v[220:223]
    s_waitcnt vmcnt(9) lgkmcnt(0)
    v_mfma_f32_16x16x32_bf16 v[168:171], v[112:115], v[40:43], v[168:171]
    ds_read_b128 v[140:143], v31 offset:21504
    v_mfma_f32_16x16x32_bf16 v[172:175], v[112:115], v[44:47], v[172:175]
    v_mfma_f32_16x16x32_bf16 v[176:179], v[116:119], v[40:43], v[176:179]
    ds_read_b128 v[144:147], v31 offset:22528
    v_mfma_f32_16x16x32_bf16 v[180:183], v[116:119], v[44:47], v[180:183]
    v_mfma_f32_16x16x32_bf16 v[184:187], v[120:123], v[40:43], v[184:187]
    ds_read_b128 v[148:151], v31 offset:23552
    v_mfma_f32_16x16x32_bf16 v[188:191], v[120:123], v[44:47], v[188:191]
    v_mfma_f32_16x16x32_bf16 v[192:195], v[124:127], v[40:43], v[192:195]
    ds_read_b128 v[152:155], v31 offset:24576
    v_mfma_f32_16x16x32_bf16 v[196:199], v[124:127], v[44:47], v[196:199]
    v_mfma_f32_16x16x32_bf16 v[200:203], v[128:131], v[40:43], v[200:203]
    ds_read_b128 v[156:159], v31 offset:25600
    v_mfma_f32_16x16x32_bf16 v[204:207], v[128:131], v[44:47], v[204:207]
    v_mfma_f32_16x16x32_bf16 v[208:211], v[132:135], v[40:43], v[208:211]
    ds_read_b128 v[160:163], v31 offset:26624
    v_mfma_f32_16x16x32_bf16 v[212:215], v[132:135], v[44:47], v[212:215]
    v_mfma_f32_16x16x32_bf16 v[216:219], v[136:139], v[40:43], v[216:219]
    ds_read_b128 v[164:167], v31 offset:27648
    v_mfma_f32_16x16x32_bf16 v[220:223], v[136:139], v[44:47], v[220:223]
    s_waitcnt vmcnt(7) lgkmcnt(0)
    v_mfma_f32_16x16x32_bf16 v[168:171], v[140:143], v[48:51], v[168:171]
    v_mfma_f32_16x16x32_bf16 v[172:175], v[140:143], v[52:55], v[172:175]
    v_mfma_f32_16x16x32_bf16 v[176:179], v[144:147], v[48:51], v[176:179]
    v_mfma_f32_16x16x32_bf16 v[180:183], v[144:147], v[52:55], v[180:183]
    v_mfma_f32_16x16x32_bf16 v[184:187], v[148:151], v[48:51], v[184:187]
    v_mfma_f32_16x16x32_bf16 v[188:191], v[148:151], v[52:55], v[188:191]
    v_mfma_f32_16x16x32_bf16 v[192:195], v[152:155], v[48:51], v[192:195]
    v_mfma_f32_16x16x32_bf16 v[196:199], v[152:155], v[52:55], v[196:199]
    v_mfma_f32_16x16x32_bf16 v[200:203], v[156:159], v[48:51], v[200:203]
    v_mfma_f32_16x16x32_bf16 v[204:207], v[156:159], v[52:55], v[204:207]
    v_mfma_f32_16x16x32_bf16 v[208:211], v[160:163], v[48:51], v[208:211]
    v_mfma_f32_16x16x32_bf16 v[212:215], v[160:163], v[52:55], v[212:215]
    v_mfma_f32_16x16x32_bf16 v[216:219], v[164:167], v[48:51], v[216:219]
    v_mfma_f32_16x16x32_bf16 v[220:223], v[164:167], v[52:55], v[220:223]
    s_waitcnt vmcnt(0)
    v_mfma_f32_16x16x32_bf16 v[168:171], v[56:59], v[240:243], v[168:171]
    v_mfma_f32_16x16x32_bf16 v[172:175], v[56:59], v[244:247], v[172:175]
    v_mfma_f32_16x16x32_bf16 v[176:179], v[60:63], v[240:243], v[176:179]
    v_mfma_f32_16x16x32_bf16 v[180:183], v[60:63], v[244:247], v[180:183]
    v_mfma_f32_16x16x32_bf16 v[184:187], v[64:67], v[240:243], v[184:187]
    v_mfma_f32_16x16x32_bf16 v[188:191], v[64:67], v[244:247], v[188:191]
    v_mfma_f32_16x16x32_bf16 v[192:195], v[68:71], v[240:243], v[192:195]
    v_mfma_f32_16x16x32_bf16 v[196:199], v[68:71], v[244:247], v[196:199]
    v_mfma_f32_16x16x32_bf16 v[200:203], v[72:75], v[240:243], v[200:203]
    v_mfma_f32_16x16x32_bf16 v[204:207], v[72:75], v[244:247], v[204:207]
    v_mfma_f32_16x16x32_bf16 v[208:211], v[76:79], v[240:243], v[208:211]
    v_mfma_f32_16x16x32_bf16 v[212:215], v[76:79], v[244:247], v[212:215]
    v_mfma_f32_16x16x32_bf16 v[216:219], v[80:83], v[240:243], v[216:219]
    v_mfma_f32_16x16x32_bf16 v[220:223], v[80:83], v[244:247], v[220:223]
    s_setprio 0
    s_add_u32 s29, s10, 16
    s_lshl_b32 s29, s29, 10
    s_add_u32 s26, s28, s29
    s_add_u32 s27, s29, 0
    s_mul_i32 s32, s31, 7
    s_min_u32 s32, s32, 209
    s_lshl_b32 s32, s32, 8
    s_mul_i32 s33, s38, 55296
    s_add_u32 s32, s32, s33
    s_add_u32 s36, s32, 14614528
    s_add_u32 s37, s36, 55296
    v_lshrrev_b32 v32, 1, v35
    v_lshlrev_b32 v33, 8, v32
    v_mul_u32_u24 v31, 55296, v32
    v_and_b32 v32, 1, v35
    v_lshlrev_b32 v32, 3, v32
    v_lshl_add_u32 v32, v34, 4, v32
    v_add_u32 v33, v33, v32
    v_add_u32 v31, v31, v32
    v_mul_f32 v168, v168, v249
    v_mul_f32 v169, v169, v249
    v_mul_f32 v170, v170, v249
    v_mul_f32 v171, v171, v249
    v_mul_f32 v176, v176, v249
    v_mul_f32 v177, v177, v249
    v_mul_f32 v178, v178, v249
    v_mul_f32 v179, v179, v249
    v_mul_f32 v200, v200, v249
    v_mul_f32 v201, v201, v249
    v_mul_f32 v202, v202, v249
    v_mul_f32 v203, v203, v249
    v_exp_f32 v168, v168
    v_exp_f32 v169, v169
    v_exp_f32 v170, v170
    v_exp_f32 v171, v171
    v_exp_f32 v176, v176
    v_exp_f32 v177, v177
    v_exp_f32 v178, v178
    v_exp_f32 v179, v179
    v_exp_f32 v200, v200
    v_exp_f32 v201, v201
    v_exp_f32 v202, v202
    v_exp_f32 v203, v203
    v_fma_f32 v168, v168, v248, v248
    v_fma_f32 v169, v169, v248, v248
    v_fma_f32 v170, v170, v248, v248
    v_fma_f32 v171, v171, v248, v248
    v_fma_f32 v176, v176, v248, v248
    v_fma_f32 v177, v177, v248, v248
    v_fma_f32 v178, v178, v248, v248
    v_fma_f32 v179, v179, v248, v248
    v_fma_f32 v200, v200, v248, v248
    v_fma_f32 v201, v201, v248, v248
    v_fma_f32 v202, v202, v248, v248
    v_fma_f32 v203, v203, v248, v248
    v_rcp_f32 v168, v168
    v_rcp_f32 v169, v169
    v_rcp_f32 v170, v170
    v_rcp_f32 v171, v171
    v_rcp_f32 v176, v176
    v_rcp_f32 v177, v177
    v_rcp_f32 v178, v178
    v_rcp_f32 v179, v179
    v_rcp_f32 v200, v200
    v_rcp_f32 v201, v201
    v_rcp_f32 v202, v202
    v_rcp_f32 v203, v203
    v_mul_f32 v168, v168, v184
    v_mul_f32 v169, v169, v185
    v_mul_f32 v170, v170, v186
    v_mul_f32 v171, v171, v187
    v_mul_f32 v176, v176, v192
    v_mul_f32 v177, v177, v193
    v_mul_f32 v178, v178, v194
    v_mul_f32 v179, v179, v195
    v_mul_f32 v200, v200, v208
    v_mul_f32 v201, v201, v209
    v_mul_f32 v202, v202, v210
    v_mul_f32 v203, v203, v211
    v_cvt_pk_bf16_f32 v140, v168, v169
    v_cvt_pk_bf16_f32 v141, v170, v171
    v_cvt_pk_bf16_f32 v142, v176, v177
    v_cvt_pk_bf16_f32 v143, v178, v179
    v_cvt_pk_bf16_f32 v144, v200, v201
    v_cvt_pk_bf16_f32 v145, v202, v203
    buffer_store_dwordx4 v[140:143], v30, s[4:7], s36 offen sc1
    buffer_store_dwordx2 v[144:145], v33, s[4:7], s36 offen offset:1024 sc1
    v_mul_f32 v172, v172, v251
    v_mul_f32 v173, v173, v251
    v_mul_f32 v174, v174, v251
    v_mul_f32 v175, v175, v251
    v_mul_f32 v180, v180, v251
    v_mul_f32 v181, v181, v251
    v_mul_f32 v182, v182, v251
    v_mul_f32 v183, v183, v251
    v_mul_f32 v204, v204, v251
    v_mul_f32 v205, v205, v251
    v_mul_f32 v206, v206, v251
    v_mul_f32 v207, v207, v251
    v_exp_f32 v172, v172
    v_exp_f32 v173, v173
    v_exp_f32 v174, v174
    v_exp_f32 v175, v175
    v_exp_f32 v180, v180
    v_exp_f32 v181, v181
    v_exp_f32 v182, v182
    v_exp_f32 v183, v183
    v_exp_f32 v204, v204
    v_exp_f32 v205, v205
    v_exp_f32 v206, v206
    v_exp_f32 v207, v207
    v_fma_f32 v172, v172, v250, v250
    v_fma_f32 v173, v173, v250, v250
    v_fma_f32 v174, v174, v250, v250
    v_fma_f32 v175, v175, v250, v250
    v_fma_f32 v180, v180, v250, v250
    v_fma_f32 v181, v181, v250, v250
    v_fma_f32 v182, v182, v250, v250
    v_fma_f32 v183, v183, v250, v250
    v_fma_f32 v204, v204, v250, v250
    v_fma_f32 v205, v205, v250, v250
    v_fma_f32 v206, v206, v250, v250
    v_fma_f32 v207, v207, v250, v250
    v_rcp_f32 v172, v172
    v_rcp_f32 v173, v173
    v_rcp_f32 v174, v174
    v_rcp_f32 v175, v175
    v_rcp_f32 v180, v180
    v_rcp_f32 v181, v181
    v_rcp_f32 v182, v182
    v_rcp_f32 v183, v183
    v_rcp_f32 v204, v204
    v_rcp_f32 v205, v205
    v_rcp_f32 v206, v206
    v_rcp_f32 v207, v207
    v_mul_f32 v172, v172, v188
    v_mul_f32 v173, v173, v189
    v_mul_f32 v174, v174, v190
    v_mul_f32 v175, v175, v191
    v_mul_f32 v180, v180, v196
    v_mul_f32 v181, v181, v197
    v_mul_f32 v182, v182, v198
    v_mul_f32 v183, v183, v199
    v_mul_f32 v204, v204, v212
    v_mul_f32 v205, v205, v213
    v_mul_f32 v206, v206, v214
    v_mul_f32 v207, v207, v215
    v_cvt_pk_bf16_f32 v148, v172, v173
    v_cvt_pk_bf16_f32 v149, v174, v175
    v_cvt_pk_bf16_f32 v150, v180, v181
    v_cvt_pk_bf16_f32 v151, v182, v183
    v_cvt_pk_bf16_f32 v152, v204, v205
    v_cvt_pk_bf16_f32 v153, v206, v207
    buffer_store_dwordx4 v[148:151], v30, s[4:7], s37 offen sc1
    buffer_store_dwordx2 v[152:153], v33, s[4:7], s37 offen offset:1024 sc1
    v_cmp_gt_u32 vcc, 32, v1
    v_permlane32_swap_b32 v216, v220
    v_permlane32_swap_b32 v217, v221
    v_permlane32_swap_b32 v218, v222
    v_permlane32_swap_b32 v219, v223
    v_cndmask_b32 v248, v250, v248, vcc
    v_cndmask_b32 v249, v251, v249, vcc
    v_mul_f32 v216, v216, v249
    v_mul_f32 v217, v217, v249
    v_mul_f32 v218, v218, v249
    v_mul_f32 v219, v219, v249
    v_exp_f32 v216, v216
    v_exp_f32 v217, v217
    v_exp_f32 v218, v218
    v_exp_f32 v219, v219
    v_fma_f32 v216, v216, v248, v248
    v_fma_f32 v217, v217, v248, v248
    v_fma_f32 v218, v218, v248, v248
    v_fma_f32 v219, v219, v248, v248
    v_rcp_f32 v216, v216
    v_rcp_f32 v217, v217
    v_rcp_f32 v218, v218
    v_rcp_f32 v219, v219
    v_mul_f32 v216, v216, v220
    v_mul_f32 v217, v217, v221
    v_mul_f32 v218, v218, v222
    v_mul_f32 v219, v219, v223
    v_cvt_pk_bf16_f32 v156, v216, v217
    v_cvt_pk_bf16_f32 v157, v218, v219
    buffer_store_dwordx2 v[156:157], v31, s[4:7], s36 offen offset:1536 sc1
    s_and_b32 s33, s30, 6
    s_mul_i32 s33, s33, 2048
    s_mul_i32 s20, s30, 16384
    s_add_u32 s20, s20, s33
    s_and_b32 s33, s31, 3
    s_lshl_b32 s33, s33, 8
    s_add_u32 s20, s20, s33
    s_add_u32 s20, s20, 524288
    s_barrier
    s_mov_b32 m0, s27
    s_add_u32 s27, s27, 8192
    buffer_load_dwordx4 v29, s[4:7], s26 offen sc1 lds
    s_add_u32 s26, s26, 8192
    s_mov_b32 m0, s27
    s_add_u32 s27, s27, 8192
    buffer_load_dwordx4 v29, s[4:7], s26 offen sc1 lds
    s_add_u32 s26, s26, 8192
    s_mov_b32 m0, s27
    s_add_u32 s27, s27, 8192
    buffer_load_dwordx4 v29, s[4:7], s26 offen sc1 lds
    s_add_u32 s26, s26, 8192
    s_mov_b32 m0, s27
    s_add_u32 s27, s27, 8192
    buffer_load_dwordx4 v29, s[4:7], s26 offen sc1 lds
    s_add_u32 s26, s26, 8192
    s_waitcnt vmcnt(4)
    s_barrier
    s_cmp_lg_u32 s10, 0
    s_cbranch_scc1 L_gu_d0_234085
    s_mov_b64 exec, 3
    v_mul_u32_u24 v36, 2048, v1
    v_mov_b32 v37, 1
    buffer_atomic_add v37, v36, s[4:7], s20 offen sc1
    s_mov_b64 exec, -1
    s_branch L_gu_d1_234086
L_gu_idle_234079:
    v_lshlrev_b32 v29, 4, v1
    s_bfe_u32 s29, s2, 0x20001
    s_lshl_b32 s29, s29, 3
    s_lshr_b32 s26, s2, 5
    s_add_u32 s29, s29, s26
    s_and_b32 s28, s2, 1
    s_lshl_b32 s28, s28, 2
    s_bfe_u32 s26, s2, 0x20003
    s_add_u32 s28, s28, s26
    s_mul_i32 s28, s28, 276480
    s_add_u32 s28, s28, 24969216
    s_add_u32 s29, s10, 0
    s_lshl_b32 s29, s29, 10
    s_add_u32 s26, s28, s29
    s_add_u32 s27, s29, 0
    s_mov_b32 m0, s27
    s_add_u32 s27, s27, 8192
    buffer_load_dwordx4 v29, s[4:7], s26 offen sc1 lds
    s_add_u32 s26, s26, 8192
    s_mov_b32 m0, s27
    s_add_u32 s27, s27, 8192
    buffer_load_dwordx4 v29, s[4:7], s26 offen sc1 lds
    s_add_u32 s26, s26, 8192
    s_mov_b32 m0, s27
    s_add_u32 s27, s27, 8192
    buffer_load_dwordx4 v29, s[4:7], s26 offen sc1 lds
    s_add_u32 s26, s26, 8192
    s_mov_b32 m0, s27
    s_add_u32 s27, s27, 8192
    buffer_load_dwordx4 v29, s[4:7], s26 offen sc1 lds
    s_add_u32 s26, s26, 8192
    s_mov_b32 m0, s27
    s_add_u32 s27, s27, 8192
    buffer_load_dwordx4 v29, s[4:7], s26 offen sc1 lds
    s_add_u32 s26, s26, 8192
    s_mov_b32 m0, s27
    s_add_u32 s27, s27, 8192
    buffer_load_dwordx4 v29, s[4:7], s26 offen sc1 lds
    s_add_u32 s26, s26, 8192
    s_cmp_eq_u32 s10, 0
    s_cbranch_scc1 L_gu_d1_234086
L_gu_d0_234085:
    s_add_u32 s29, s10, 47
    s_lshl_b32 s29, s29, 10
    s_add_u32 s26, s28, s29
    s_add_u32 s27, s29, 0
    s_mov_b32 m0, s27
    s_add_u32 s27, s27, 7168
    buffer_load_dwordx4 v29, s[4:7], s26 offen sc1 lds
    s_add_u32 s26, s26, 7168
    s_mov_b32 m0, s27
    s_add_u32 s27, s27, 7168
    buffer_load_dwordx4 v29, s[4:7], s26 offen sc1 lds
    s_add_u32 s26, s26, 7168
    s_mov_b32 m0, s27
    s_add_u32 s27, s27, 7168
    buffer_load_dwordx4 v29, s[4:7], s26 offen sc1 lds
    s_add_u32 s26, s26, 7168
    s_mov_b32 m0, s27
    s_add_u32 s27, s27, 7168
    buffer_load_dwordx4 v29, s[4:7], s26 offen sc1 lds
    s_add_u32 s26, s26, 7168
    s_mov_b32 m0, s27
    s_add_u32 s27, s27, 7168
    buffer_load_dwordx4 v29, s[4:7], s26 offen sc1 lds
    s_add_u32 s26, s26, 7168
    s_mov_b32 m0, s27
    s_add_u32 s27, s27, 7168
    buffer_load_dwordx4 v29, s[4:7], s26 offen sc1 lds
    s_add_u32 s26, s26, 7168
    s_mov_b32 m0, s27
    s_add_u32 s27, s27, 7168
    buffer_load_dwordx4 v29, s[4:7], s26 offen sc1 lds
    s_add_u32 s26, s26, 7168
    s_mov_b32 m0, s27
    s_add_u32 s27, s27, 7168
    buffer_load_dwordx4 v29, s[4:7], s26 offen sc1 lds
    s_add_u32 s26, s26, 7168
    s_mov_b32 m0, s27
    s_add_u32 s27, s27, 7168
    buffer_load_dwordx4 v29, s[4:7], s26 offen sc1 lds
    s_add_u32 s26, s26, 7168
    s_mov_b32 m0, s27
    s_add_u32 s27, s27, 7168
    buffer_load_dwordx4 v29, s[4:7], s26 offen sc1 lds
    s_add_u32 s26, s26, 7168
    s_mov_b32 m0, s27
    s_add_u32 s27, s27, 7168
    buffer_load_dwordx4 v29, s[4:7], s26 offen sc1 lds
    s_add_u32 s26, s26, 7168
    s_mov_b32 m0, s27
    s_add_u32 s27, s27, 7168
    buffer_load_dwordx4 v29, s[4:7], s26 offen sc1 lds
    s_add_u32 s26, s26, 7168
    s_mov_b32 m0, s27
    s_add_u32 s27, s27, 7168
    buffer_load_dwordx4 v29, s[4:7], s26 offen sc1 lds
    s_add_u32 s26, s26, 7168
    s_mov_b32 m0, s27
    s_add_u32 s27, s27, 7168
    buffer_load_dwordx4 v29, s[4:7], s26 offen sc1 lds
    s_add_u32 s26, s26, 7168
    s_mov_b32 m0, s27
    s_add_u32 s27, s27, 7168
    buffer_load_dwordx4 v29, s[4:7], s26 offen sc1 lds
    s_add_u32 s26, s26, 7168
    s_mov_b32 m0, s27
    s_add_u32 s27, s27, 7168
    buffer_load_dwordx4 v29, s[4:7], s26 offen sc1 lds
    s_add_u32 s26, s26, 7168
L_gu_d1_234086:
    s_bfe_u32 s30, s2, 0x20001
    s_lshl_b32 s30, s30, 3
    s_lshr_b32 s32, s2, 5
    s_add_u32 s30, s30, s32
    s_and_b32 s31, s2, 1
    s_lshl_b32 s31, s31, 2
    s_bfe_u32 s32, s2, 0x20003
    s_add_u32 s31, s31, s32
    s_bfe_u32 s34, s10, 0x10001
    s_lshr_b32 s35, s10, 2
    s_lshl_b32 s39, s35, 3
    s_lshl_b32 s35, s35, 1
    s_and_b32 s32, s10, 1
    s_add_u32 s35, s35, s32
    s_add_u32 s39, s39, s32
    s_and_b32 s32, s30, 3
    s_lshl_b32 s32, s32, 1
    s_add_u32 s39, s39, s32
    s_lshr_b32 s32, s30, 2
    s_lshl_b32 s32, s32, 4
    s_add_u32 s39, s39, s32
    v_lshlrev_b32 v30, 4, v1
    v_and_b32 v36, 15, v1
    v_lshrrev_b32 v37, 4, v1
    v_lshlrev_b32 v34, 5, v37
    v_lshlrev_b32 v35, 4, v37
    v_lshlrev_b32 v40, 8, v37
    v_lshl_add_u32 v40, v36, 3, v40
    s_mul_i32 s38, s39, 20480
    s_mul_i32 s37, s31, 160
    s_add_u32 s38, s38, s37
    v_mul_u32_u24 v38, 1280, v36
    v_add_u32 v38, s38, v38
    v_lshl_add_u32 v39, v37, 3, v38
    v_add_u32 v39, 128, v39
    v_lshl_add_u32 v38, v37, 4, v38
    s_lshl_b32 s37, s34, 6
    v_add_u32 v38, s37, v38
    s_mul_i32 s38, s39, 54
    s_add_u32 s38, s38, s34
    s_lshl_b32 s38, s38, 10
    s_add_u32 s38, s38, 14614528
    s_add_u32 s42, s38, 4096
    s_add_u32 s42, s42, s4
    s_addc_u32 s43, s5, 0
    s_mul_i32 s32, s34, 7168
    v_add_u32 v31, s32, v30
    s_mul_i32 s32, s34, 3072
    s_add_u32 s32, s32, 2048
    v_add_u32 v32, s32, v30
    s_mul_i32 s32, s34, 5120
    s_add_u32 s32, s32, 4096
    v_add_u32 v33, s32, v30
    s_cmp_lg_u32 s10, 0
    s_cbranch_scc1 L_proj_nopoll_234088
    s_lshr_b32 s32, s30, 2
    s_mul_i32 s32, s32, 16384
    s_bfe_u32 s33, s2, 196608
    s_mul_i32 s33, s33, 2048
    s_add_u32 s32, s32, s33
    s_add_u32 s32, s32, 524288
    s_mov_b64 exec, 15
    v_lshlrev_b32 v42, 8, v1
    v_mov_b32 v43, 8
    s_mov_b32 s33, 1048576
    v_writelane_b32 v43, 7, 3
L_poll_234089:
    buffer_load_dword v44, v42, s[4:7], s32 offen sc1
    s_sub_u32 s33, s33, 1
    s_cbranch_scc1 L_poll_out_234090
    s_waitcnt vmcnt(0)
    v_cmp_gt_u32 vcc, v43, v44
    s_nop 0
    s_cbranch_vccz L_poll_out_234090
    s_sleep 0
    s_branch L_poll_234089
L_poll_out_234090:
    s_waitcnt vmcnt(0)
    s_mov_b64 exec, -1
    s_branch L_proj_bar_234091
L_proj_nopoll_234088:
    s_waitcnt vmcnt(0)
L_proj_bar_234091:
    s_waitcnt lgkmcnt(0)
    s_barrier
    s_mul_i32 s40, s31, 276480
    s_add_u32 s40, s40, 24969216
    buffer_load_dwordx4 v[48:51], v30, s[4:7], s38 offen offset:0 sc1
    buffer_load_dwordx4 v[52:55], v30, s[4:7], s38 offen offset:2048 sc1
    s_add_u32 s38, s38, 4096
    buffer_load_dwordx4 v[56:59], v30, s[4:7], s38 offen offset:0 sc1
    buffer_load_dwordx4 v[60:63], v30, s[4:7], s38 offen offset:2048 sc1
    s_add_u32 s38, s38, 4096
    buffer_load_dwordx4 v[64:67], v30, s[4:7], s38 offen offset:0 sc1
    buffer_load_dwordx4 v[68:71], v30, s[4:7], s38 offen offset:2048 sc1
    s_add_u32 s38, s38, 4096
    ds_read_b128 v[156:159], v31 offset:0
    ds_read_b128 v[160:163], v31 offset:1024
    ds_read_b128 v[164:167], v32 offset:0
    ds_read_b128 v[168:171], v32 offset:1024
    ds_read_b128 v[172:175], v33 offset:0
    ds_read_b128 v[176:179], v31 offset:10240
    ds_read_b128 v[180:183], v31 offset:11264
    ds_read_b128 v[184:187], v32 offset:10240
    ds_read_b128 v[188:191], v32 offset:11264
    ds_read_b128 v[192:195], v33 offset:10240
    s_waitcnt vmcnt(5) lgkmcnt(5)
    v_mfma_f32_16x16x32_bf16 v[216:219], v[156:159], v[48:51], 0
    ds_read_b128 v[196:199], v31 offset:20480
    v_mfma_f32_16x16x32_bf16 v[220:223], v[160:163], v[48:51], 0
    ds_read_b128 v[200:203], v31 offset:21504
    v_mfma_f32_16x16x32_bf16 v[224:227], v[164:167], v[48:51], 0
    ds_read_b128 v[204:207], v32 offset:20480
    v_mfma_f32_16x16x32_bf16 v[228:231], v[168:171], v[48:51], 0
    ds_read_b128 v[208:211], v32 offset:21504
    v_mfma_f32_16x16x32_bf16 v[232:235], v[172:175], v[48:51], 0
    ds_read_b128 v[212:215], v33 offset:20480
    buffer_load_dwordx4 v[72:75], v30, s[4:7], s38 offen offset:0 sc1
    s_waitcnt vmcnt(5) lgkmcnt(5)
    v_mfma_f32_16x16x32_bf16 v[216:219], v[176:179], v[52:55], v[216:219]
    ds_read_b128 v[156:159], v31 offset:30720
    v_mfma_f32_16x16x32_bf16 v[220:223], v[180:183], v[52:55], v[220:223]
    ds_read_b128 v[160:163], v31 offset:31744
    v_mfma_f32_16x16x32_bf16 v[224:227], v[184:187], v[52:55], v[224:227]
    ds_read_b128 v[164:167], v32 offset:30720
    v_mfma_f32_16x16x32_bf16 v[228:231], v[188:191], v[52:55], v[228:231]
    ds_read_b128 v[168:171], v32 offset:31744
    v_mfma_f32_16x16x32_bf16 v[232:235], v[192:195], v[52:55], v[232:235]
    ds_read_b128 v[172:175], v33 offset:30720
    buffer_load_dwordx4 v[76:79], v30, s[4:7], s38 offen offset:2048 sc1
    s_add_u32 s38, s38, 4096
    s_waitcnt vmcnt(5) lgkmcnt(0)
    s_barrier
    v_mfma_f32_16x16x32_bf16 v[216:219], v[196:199], v[56:59], v[216:219]
    ds_read_b128 v[176:179], v31 offset:40960
    v_mfma_f32_16x16x32_bf16 v[220:223], v[200:203], v[56:59], v[220:223]
    ds_read_b128 v[180:183], v31 offset:41984
    v_mfma_f32_16x16x32_bf16 v[224:227], v[204:207], v[56:59], v[224:227]
    ds_read_b128 v[184:187], v32 offset:40960
    v_mfma_f32_16x16x32_bf16 v[228:231], v[208:211], v[56:59], v[228:231]
    ds_read_b128 v[188:191], v32 offset:41984
    v_mfma_f32_16x16x32_bf16 v[232:235], v[212:215], v[56:59], v[232:235]
    ds_read_b128 v[192:195], v33 offset:40960
    s_add_u32 s32, s10, 160
    s_lshl_b32 s32, s32, 10
    s_add_u32 s36, s40, s32
    s_add_u32 s37, s32, 4294803456
    s_mov_b32 m0, s37
    s_add_u32 s37, s37, 8192
    buffer_load_dwordx4 v30, s[4:7], s36 offen sc1 lds
    s_add_u32 s36, s36, 8192
    s_mov_b32 m0, s37
    s_add_u32 s37, s37, 8192
    buffer_load_dwordx4 v30, s[4:7], s36 offen sc1 lds
    s_add_u32 s36, s36, 8192
    s_mov_b32 m0, s37
    s_add_u32 s37, s37, 8192
    buffer_load_dwordx4 v30, s[4:7], s36 offen sc1 lds
    s_add_u32 s36, s36, 8192
    s_mov_b32 m0, s37
    s_add_u32 s37, s37, 8192
    buffer_load_dwordx4 v30, s[4:7], s36 offen sc1 lds
    s_add_u32 s36, s36, 8192
    s_mov_b32 m0, s37
    s_add_u32 s37, s37, 8192
    buffer_load_dwordx4 v30, s[4:7], s36 offen sc1 lds
    s_add_u32 s36, s36, 8192
    buffer_load_dwordx4 v[80:83], v30, s[4:7], s38 offen offset:0 sc1
    v_add_u32 v31, 51200, v31
    v_add_u32 v32, 51200, v32
    v_add_u32 v33, 51200, v33
    s_waitcnt vmcnt(10)
    v_mfma_f32_16x16x32_bf16 v[216:219], v[156:159], v[60:63], v[216:219]
    ds_read_b128 v[196:199], v31 offset:0
    v_mfma_f32_16x16x32_bf16 v[220:223], v[160:163], v[60:63], v[220:223]
    ds_read_b128 v[200:203], v31 offset:1024
    v_mfma_f32_16x16x32_bf16 v[224:227], v[164:167], v[60:63], v[224:227]
    ds_read_b128 v[204:207], v32 offset:0
    v_mfma_f32_16x16x32_bf16 v[228:231], v[168:171], v[60:63], v[228:231]
    ds_read_b128 v[208:211], v32 offset:1024
    v_mfma_f32_16x16x32_bf16 v[232:235], v[172:175], v[60:63], v[232:235]
    ds_read_b128 v[212:215], v33 offset:0
    buffer_load_dwordx4 v[84:87], v30, s[4:7], s38 offen offset:2048 sc1
    s_add_u32 s38, s38, 4096
    s_waitcnt vmcnt(10) lgkmcnt(5)
    v_mfma_f32_16x16x32_bf16 v[216:219], v[176:179], v[64:67], v[216:219]
    ds_read_b128 v[156:159], v31 offset:10240
    v_mfma_f32_16x16x32_bf16 v[220:223], v[180:183], v[64:67], v[220:223]
    ds_read_b128 v[160:163], v31 offset:11264
    v_mfma_f32_16x16x32_bf16 v[224:227], v[184:187], v[64:67], v[224:227]
    ds_read_b128 v[164:167], v32 offset:10240
    v_mfma_f32_16x16x32_bf16 v[228:231], v[188:191], v[64:67], v[228:231]
    ds_read_b128 v[168:171], v32 offset:11264
    v_mfma_f32_16x16x32_bf16 v[232:235], v[192:195], v[64:67], v[232:235]
    ds_read_b128 v[172:175], v33 offset:10240
    buffer_load_dwordx4 v[88:91], v30, s[4:7], s38 offen offset:0 sc1
    s_waitcnt vmcnt(10) lgkmcnt(5)
    v_mfma_f32_16x16x32_bf16 v[216:219], v[196:199], v[68:71], v[216:219]
    ds_read_b128 v[176:179], v31 offset:20480
    v_mfma_f32_16x16x32_bf16 v[220:223], v[200:203], v[68:71], v[220:223]
    ds_read_b128 v[180:183], v31 offset:21504
    v_mfma_f32_16x16x32_bf16 v[224:227], v[204:207], v[68:71], v[224:227]
    ds_read_b128 v[184:187], v32 offset:20480
    v_mfma_f32_16x16x32_bf16 v[228:231], v[208:211], v[68:71], v[228:231]
    ds_read_b128 v[188:191], v32 offset:21504
    v_mfma_f32_16x16x32_bf16 v[232:235], v[212:215], v[68:71], v[232:235]
    ds_read_b128 v[192:195], v33 offset:20480
    buffer_load_dwordx4 v[92:95], v30, s[4:7], s38 offen offset:2048 sc1
    s_add_u32 s38, s38, 4096
    s_waitcnt vmcnt(10) lgkmcnt(0)
    s_barrier
    v_mfma_f32_16x16x32_bf16 v[216:219], v[156:159], v[72:75], v[216:219]
    ds_read_b128 v[196:199], v31 offset:30720
    v_mfma_f32_16x16x32_bf16 v[220:223], v[160:163], v[72:75], v[220:223]
    ds_read_b128 v[200:203], v31 offset:31744
    v_mfma_f32_16x16x32_bf16 v[224:227], v[164:167], v[72:75], v[224:227]
    ds_read_b128 v[204:207], v32 offset:30720
    v_mfma_f32_16x16x32_bf16 v[228:231], v[168:171], v[72:75], v[228:231]
    ds_read_b128 v[208:211], v32 offset:31744
    v_mfma_f32_16x16x32_bf16 v[232:235], v[172:175], v[72:75], v[232:235]
    ds_read_b128 v[212:215], v33 offset:30720
    s_add_u32 s32, s10, 200
    s_lshl_b32 s32, s32, 10
    s_add_u32 s36, s40, s32
    s_add_u32 s37, s32, 4294803456
    s_mov_b32 m0, s37
    s_add_u32 s37, s37, 8192
    buffer_load_dwordx4 v30, s[4:7], s36 offen sc1 lds
    s_add_u32 s36, s36, 8192
    s_mov_b32 m0, s37
    s_add_u32 s37, s37, 8192
    buffer_load_dwordx4 v30, s[4:7], s36 offen sc1 lds
    s_add_u32 s36, s36, 8192
    s_mov_b32 m0, s37
    s_add_u32 s37, s37, 8192
    buffer_load_dwordx4 v30, s[4:7], s36 offen sc1 lds
    s_add_u32 s36, s36, 8192
    s_mov_b32 m0, s37
    s_add_u32 s37, s37, 8192
    buffer_load_dwordx4 v30, s[4:7], s36 offen sc1 lds
    s_add_u32 s36, s36, 8192
    s_mov_b32 m0, s37
    s_add_u32 s37, s37, 8192
    buffer_load_dwordx4 v30, s[4:7], s36 offen sc1 lds
    s_add_u32 s36, s36, 8192
    buffer_load_dwordx4 v[96:99], v30, s[4:7], s38 offen offset:0 sc1
    s_waitcnt vmcnt(15)
    v_mfma_f32_16x16x32_bf16 v[216:219], v[176:179], v[76:79], v[216:219]
    ds_read_b128 v[156:159], v31 offset:40960
    v_mfma_f32_16x16x32_bf16 v[220:223], v[180:183], v[76:79], v[220:223]
    ds_read_b128 v[160:163], v31 offset:41984
    v_mfma_f32_16x16x32_bf16 v[224:227], v[184:187], v[76:79], v[224:227]
    ds_read_b128 v[164:167], v32 offset:40960
    v_mfma_f32_16x16x32_bf16 v[228:231], v[188:191], v[76:79], v[228:231]
    ds_read_b128 v[168:171], v32 offset:41984
    v_mfma_f32_16x16x32_bf16 v[232:235], v[192:195], v[76:79], v[232:235]
    ds_read_b128 v[172:175], v33 offset:40960
    buffer_load_dwordx4 v[100:103], v30, s[4:7], s38 offen offset:2048 sc1
    s_add_u32 s38, s38, 4096
    v_add_u32 v31, 51200, v31
    v_add_u32 v32, 51200, v32
    v_add_u32 v33, 51200, v33
    s_waitcnt vmcnt(10) lgkmcnt(5)
    v_mfma_f32_16x16x32_bf16 v[216:219], v[196:199], v[80:83], v[216:219]
    ds_read_b128 v[176:179], v31 offset:0
    v_mfma_f32_16x16x32_bf16 v[220:223], v[200:203], v[80:83], v[220:223]
    ds_read_b128 v[180:183], v31 offset:1024
    v_mfma_f32_16x16x32_bf16 v[224:227], v[204:207], v[80:83], v[224:227]
    ds_read_b128 v[184:187], v32 offset:0
    v_mfma_f32_16x16x32_bf16 v[228:231], v[208:211], v[80:83], v[228:231]
    ds_read_b128 v[188:191], v32 offset:1024
    v_mfma_f32_16x16x32_bf16 v[232:235], v[212:215], v[80:83], v[232:235]
    ds_read_b128 v[192:195], v33 offset:0
    buffer_load_dwordx4 v[104:107], v30, s[4:7], s38 offen offset:0 sc1
    s_waitcnt vmcnt(10) lgkmcnt(5)
    v_mfma_f32_16x16x32_bf16 v[216:219], v[156:159], v[84:87], v[216:219]
    ds_read_b128 v[196:199], v31 offset:10240
    v_mfma_f32_16x16x32_bf16 v[220:223], v[160:163], v[84:87], v[220:223]
    ds_read_b128 v[200:203], v31 offset:11264
    v_mfma_f32_16x16x32_bf16 v[224:227], v[164:167], v[84:87], v[224:227]
    ds_read_b128 v[204:207], v32 offset:10240
    v_mfma_f32_16x16x32_bf16 v[228:231], v[168:171], v[84:87], v[228:231]
    ds_read_b128 v[208:211], v32 offset:11264
    v_mfma_f32_16x16x32_bf16 v[232:235], v[172:175], v[84:87], v[232:235]
    ds_read_b128 v[212:215], v33 offset:10240
    buffer_load_dwordx4 v[108:111], v30, s[4:7], s38 offen offset:2048 sc1
    s_add_u32 s38, s38, 4096
    s_waitcnt vmcnt(10) lgkmcnt(0)
    s_barrier
    v_mfma_f32_16x16x32_bf16 v[216:219], v[176:179], v[88:91], v[216:219]
    ds_read_b128 v[156:159], v31 offset:20480
    v_mfma_f32_16x16x32_bf16 v[220:223], v[180:183], v[88:91], v[220:223]
    ds_read_b128 v[160:163], v31 offset:21504
    v_mfma_f32_16x16x32_bf16 v[224:227], v[184:187], v[88:91], v[224:227]
    ds_read_b128 v[164:167], v32 offset:20480
    v_mfma_f32_16x16x32_bf16 v[228:231], v[188:191], v[88:91], v[228:231]
    ds_read_b128 v[168:171], v32 offset:21504
    v_mfma_f32_16x16x32_bf16 v[232:235], v[192:195], v[88:91], v[232:235]
    ds_read_b128 v[172:175], v33 offset:20480
    s_add_u32 s32, s10, 240
    s_lshl_b32 s32, s32, 10
    s_add_u32 s36, s40, s32
    s_add_u32 s37, s32, 4294803456
    s_mov_b32 m0, s37
    s_add_u32 s37, s37, 8192
    buffer_load_dwordx4 v30, s[4:7], s36 offen sc1 lds
    s_add_u32 s36, s36, 8192
    s_mov_b32 m0, s37
    s_add_u32 s37, s37, 8192
    buffer_load_dwordx4 v30, s[4:7], s36 offen sc1 lds
    s_add_u32 s36, s36, 8192
    s_mov_b32 m0, s37
    s_add_u32 s37, s37, 8192
    buffer_load_dwordx4 v30, s[4:7], s36 offen sc1 lds
    s_add_u32 s36, s36, 8192
    s_cmp_ge_u32 s10, 6
    s_cbranch_scc1 L_feed_skip_234092
    s_mov_b32 m0, s37
    s_add_u32 s37, s37, 8192
    buffer_load_dwordx4 v30, s[4:7], s36 offen sc1 lds
    s_add_u32 s36, s36, 8192
L_feed_skip_234092:
    buffer_load_dwordx4 v[112:115], v30, s[4:7], s38 offen offset:0 sc1
    s_waitcnt vmcnt(13)
    v_mfma_f32_16x16x32_bf16 v[216:219], v[196:199], v[92:95], v[216:219]
    ds_read_b128 v[176:179], v31 offset:30720
    v_mfma_f32_16x16x32_bf16 v[220:223], v[200:203], v[92:95], v[220:223]
    ds_read_b128 v[180:183], v31 offset:31744
    v_mfma_f32_16x16x32_bf16 v[224:227], v[204:207], v[92:95], v[224:227]
    ds_read_b128 v[184:187], v32 offset:30720
    v_mfma_f32_16x16x32_bf16 v[228:231], v[208:211], v[92:95], v[228:231]
    ds_read_b128 v[188:191], v32 offset:31744
    v_mfma_f32_16x16x32_bf16 v[232:235], v[212:215], v[92:95], v[232:235]
    ds_read_b128 v[192:195], v33 offset:30720
    buffer_load_dwordx4 v[116:119], v30, s[4:7], s38 offen offset:2048 sc1
    s_add_u32 s38, s38, 4096
    s_waitcnt vmcnt(8) lgkmcnt(5)
    v_mfma_f32_16x16x32_bf16 v[216:219], v[156:159], v[96:99], v[216:219]
    ds_read_b128 v[196:199], v31 offset:40960
    v_mfma_f32_16x16x32_bf16 v[220:223], v[160:163], v[96:99], v[220:223]
    ds_read_b128 v[200:203], v31 offset:41984
    v_mfma_f32_16x16x32_bf16 v[224:227], v[164:167], v[96:99], v[224:227]
    ds_read_b128 v[204:207], v32 offset:40960
    v_mfma_f32_16x16x32_bf16 v[228:231], v[168:171], v[96:99], v[228:231]
    ds_read_b128 v[208:211], v32 offset:41984
    v_mfma_f32_16x16x32_bf16 v[232:235], v[172:175], v[96:99], v[232:235]
    ds_read_b128 v[212:215], v33 offset:40960
    buffer_load_dwordx4 v[120:123], v30, s[4:7], s38 offen offset:0 sc1
    v_add_u32 v31, 51200, v31
    v_add_u32 v32, 51200, v32
    v_add_u32 v33, 51200, v33
    s_waitcnt vmcnt(8) lgkmcnt(5)
    v_mfma_f32_16x16x32_bf16 v[216:219], v[176:179], v[100:103], v[216:219]
    ds_read_b128 v[156:159], v31 offset:0
    v_mfma_f32_16x16x32_bf16 v[220:223], v[180:183], v[100:103], v[220:223]
    ds_read_b128 v[160:163], v31 offset:1024
    v_mfma_f32_16x16x32_bf16 v[224:227], v[184:187], v[100:103], v[224:227]
    ds_read_b128 v[164:167], v32 offset:0
    v_mfma_f32_16x16x32_bf16 v[228:231], v[188:191], v[100:103], v[228:231]
    ds_read_b128 v[168:171], v32 offset:1024
    v_mfma_f32_16x16x32_bf16 v[232:235], v[192:195], v[100:103], v[232:235]
    ds_read_b128 v[172:175], v33 offset:0
    buffer_load_dwordx4 v[124:127], v30, s[4:7], s38 offen offset:2048 sc1
    s_add_u32 s38, s38, 4096
    s_waitcnt vmcnt(8) lgkmcnt(0)
    s_barrier
    v_add_u32 v31, 4294813696, v31
    v_add_u32 v32, 4294813696, v32
    v_add_u32 v33, 4294813696, v33
    v_mfma_f32_16x16x32_bf16 v[216:219], v[196:199], v[104:107], v[216:219]
    ds_read_b128 v[176:179], v31 offset:0
    v_mfma_f32_16x16x32_bf16 v[220:223], v[200:203], v[104:107], v[220:223]
    ds_read_b128 v[180:183], v31 offset:1024
    v_mfma_f32_16x16x32_bf16 v[224:227], v[204:207], v[104:107], v[224:227]
    ds_read_b128 v[184:187], v32 offset:0
    v_mfma_f32_16x16x32_bf16 v[228:231], v[208:211], v[104:107], v[228:231]
    ds_read_b128 v[188:191], v32 offset:1024
    v_mfma_f32_16x16x32_bf16 v[232:235], v[212:215], v[104:107], v[232:235]
    ds_read_b128 v[192:195], v33 offset:0
    buffer_load_dwordx4 v[128:131], v30, s[4:7], s38 offen offset:0 sc1
    s_waitcnt vmcnt(8)
    v_mfma_f32_16x16x32_bf16 v[216:219], v[156:159], v[108:111], v[216:219]
    ds_read_b128 v[196:199], v31 offset:10240
    v_mfma_f32_16x16x32_bf16 v[220:223], v[160:163], v[108:111], v[220:223]
    ds_read_b128 v[200:203], v31 offset:11264
    v_mfma_f32_16x16x32_bf16 v[224:227], v[164:167], v[108:111], v[224:227]
    ds_read_b128 v[204:207], v32 offset:10240
    v_mfma_f32_16x16x32_bf16 v[228:231], v[168:171], v[108:111], v[228:231]
    ds_read_b128 v[208:211], v32 offset:11264
    v_mfma_f32_16x16x32_bf16 v[232:235], v[172:175], v[108:111], v[232:235]
    ds_read_b128 v[212:215], v33 offset:10240
    buffer_load_dwordx4 v[132:135], v30, s[4:7], s38 offen offset:2048 sc1
    s_add_u32 s38, s38, 4096
    s_waitcnt vmcnt(5) lgkmcnt(5)
    v_mfma_f32_16x16x32_bf16 v[216:219], v[176:179], v[112:115], v[216:219]
    ds_read_b128 v[156:159], v31 offset:20480
    v_mfma_f32_16x16x32_bf16 v[220:223], v[180:183], v[112:115], v[220:223]
    ds_read_b128 v[160:163], v31 offset:21504
    v_mfma_f32_16x16x32_bf16 v[224:227], v[184:187], v[112:115], v[224:227]
    ds_read_b128 v[164:167], v32 offset:20480
    v_mfma_f32_16x16x32_bf16 v[228:231], v[188:191], v[112:115], v[228:231]
    ds_read_b128 v[168:171], v32 offset:21504
    v_mfma_f32_16x16x32_bf16 v[232:235], v[192:195], v[112:115], v[232:235]
    ds_read_b128 v[172:175], v33 offset:20480
    buffer_load_dwordx4 v[136:139], v30, s[4:7], s38 offen offset:0 sc1
    s_waitcnt vmcnt(5) lgkmcnt(5)
    v_mfma_f32_16x16x32_bf16 v[216:219], v[196:199], v[116:119], v[216:219]
    ds_read_b128 v[176:179], v31 offset:30720
    v_mfma_f32_16x16x32_bf16 v[220:223], v[200:203], v[116:119], v[220:223]
    ds_read_b128 v[180:183], v31 offset:31744
    v_mfma_f32_16x16x32_bf16 v[224:227], v[204:207], v[116:119], v[224:227]
    ds_read_b128 v[184:187], v32 offset:30720
    v_mfma_f32_16x16x32_bf16 v[228:231], v[208:211], v[116:119], v[228:231]
    ds_read_b128 v[188:191], v32 offset:31744
    v_mfma_f32_16x16x32_bf16 v[232:235], v[212:215], v[116:119], v[232:235]
    ds_read_b128 v[192:195], v33 offset:30720
    buffer_load_dwordx4 v[140:143], v30, s[4:7], s38 offen offset:2048 sc1
    s_add_u32 s38, s38, 4096
    s_waitcnt vmcnt(5) lgkmcnt(0)
    s_barrier
    v_mfma_f32_16x16x32_bf16 v[216:219], v[156:159], v[120:123], v[216:219]
    ds_read_b128 v[196:199], v31 offset:40960
    v_mfma_f32_16x16x32_bf16 v[220:223], v[160:163], v[120:123], v[220:223]
    ds_read_b128 v[200:203], v31 offset:41984
    v_mfma_f32_16x16x32_bf16 v[224:227], v[164:167], v[120:123], v[224:227]
    ds_read_b128 v[204:207], v32 offset:40960
    v_mfma_f32_16x16x32_bf16 v[228:231], v[168:171], v[120:123], v[228:231]
    ds_read_b128 v[208:211], v32 offset:41984
    v_mfma_f32_16x16x32_bf16 v[232:235], v[172:175], v[120:123], v[232:235]
    ds_read_b128 v[212:215], v33 offset:40960
    buffer_load_dwordx4 v[144:147], v30, s[4:7], s38 offen offset:0 sc1
    v_add_u32 v31, 51200, v31
    v_add_u32 v32, 51200, v32
    v_add_u32 v33, 51200, v33
    s_waitcnt vmcnt(5)
    v_mfma_f32_16x16x32_bf16 v[216:219], v[176:179], v[124:127], v[216:219]
    ds_read_b128 v[156:159], v31 offset:0
    v_mfma_f32_16x16x32_bf16 v[220:223], v[180:183], v[124:127], v[220:223]
    ds_read_b128 v[160:163], v31 offset:1024
    v_mfma_f32_16x16x32_bf16 v[224:227], v[184:187], v[124:127], v[224:227]
    ds_read_b128 v[164:167], v32 offset:0
    v_mfma_f32_16x16x32_bf16 v[228:231], v[188:191], v[124:127], v[228:231]
    ds_read_b128 v[168:171], v32 offset:1024
    v_mfma_f32_16x16x32_bf16 v[232:235], v[192:195], v[124:127], v[232:235]
    ds_read_b128 v[172:175], v33 offset:0
    buffer_load_dwordx4 v[148:151], v30, s[4:7], s38 offen offset:2048 sc1
    s_add_u32 s38, s38, 4096
    s_waitcnt vmcnt(5) lgkmcnt(5)
    v_mfma_f32_16x16x32_bf16 v[216:219], v[196:199], v[128:131], v[216:219]
    ds_read_b128 v[176:179], v31 offset:10240
    v_mfma_f32_16x16x32_bf16 v[220:223], v[200:203], v[128:131], v[220:223]
    ds_read_b128 v[180:183], v31 offset:11264
    v_mfma_f32_16x16x32_bf16 v[224:227], v[204:207], v[128:131], v[224:227]
    ds_read_b128 v[184:187], v32 offset:10240
    v_mfma_f32_16x16x32_bf16 v[228:231], v[208:211], v[128:131], v[228:231]
    ds_read_b128 v[188:191], v32 offset:11264
    v_mfma_f32_16x16x32_bf16 v[232:235], v[212:215], v[128:131], v[232:235]
    ds_read_b128 v[192:195], v33 offset:10240
    buffer_load_dwordx4 v[152:155], v30, s[4:7], s38 offen offset:0 sc1
    s_waitcnt vmcnt(5) lgkmcnt(5)
    v_mfma_f32_16x16x32_bf16 v[216:219], v[156:159], v[132:135], v[216:219]
    ds_read_b128 v[196:199], v31 offset:20480
    v_mfma_f32_16x16x32_bf16 v[220:223], v[160:163], v[132:135], v[220:223]
    ds_read_b128 v[200:203], v31 offset:21504
    v_mfma_f32_16x16x32_bf16 v[224:227], v[164:167], v[132:135], v[224:227]
    ds_read_b128 v[204:207], v32 offset:20480
    v_mfma_f32_16x16x32_bf16 v[228:231], v[168:171], v[132:135], v[228:231]
    ds_read_b128 v[208:211], v32 offset:21504
    v_mfma_f32_16x16x32_bf16 v[232:235], v[172:175], v[132:135], v[232:235]
    ds_read_b128 v[212:215], v33 offset:20480
    s_waitcnt vmcnt(4) lgkmcnt(0)
    s_barrier
    v_mfma_f32_16x16x32_bf16 v[216:219], v[176:179], v[136:139], v[216:219]
    ds_read_b128 v[156:159], v31 offset:30720
    v_mfma_f32_16x16x32_bf16 v[220:223], v[180:183], v[136:139], v[220:223]
    ds_read_b128 v[160:163], v31 offset:31744
    v_mfma_f32_16x16x32_bf16 v[224:227], v[184:187], v[136:139], v[224:227]
    ds_read_b128 v[164:167], v32 offset:30720
    v_mfma_f32_16x16x32_bf16 v[228:231], v[188:191], v[136:139], v[228:231]
    ds_read_b128 v[168:171], v32 offset:31744
    v_mfma_f32_16x16x32_bf16 v[232:235], v[192:195], v[136:139], v[232:235]
    ds_read_b128 v[172:175], v33 offset:30720
    s_waitcnt vmcnt(3)
    v_mfma_f32_16x16x32_bf16 v[216:219], v[196:199], v[140:143], v[216:219]
    ds_read_b128 v[176:179], v31 offset:40960
    v_mfma_f32_16x16x32_bf16 v[220:223], v[200:203], v[140:143], v[220:223]
    ds_read_b128 v[180:183], v31 offset:41984
    v_mfma_f32_16x16x32_bf16 v[224:227], v[204:207], v[140:143], v[224:227]
    ds_read_b128 v[184:187], v32 offset:40960
    v_mfma_f32_16x16x32_bf16 v[228:231], v[208:211], v[140:143], v[228:231]
    ds_read_b128 v[188:191], v32 offset:41984
    v_mfma_f32_16x16x32_bf16 v[232:235], v[212:215], v[140:143], v[232:235]
    ds_read_b128 v[192:195], v33 offset:40960
    v_add_u32 v31, 51200, v31
    v_add_u32 v32, 51200, v32
    v_add_u32 v33, 51200, v33
    s_waitcnt vmcnt(2) lgkmcnt(5)
    v_mfma_f32_16x16x32_bf16 v[216:219], v[156:159], v[144:147], v[216:219]
    ds_read_b128 v[196:199], v31 offset:0
    v_mfma_f32_16x16x32_bf16 v[220:223], v[160:163], v[144:147], v[220:223]
    ds_read_b128 v[200:203], v31 offset:1024
    v_mfma_f32_16x16x32_bf16 v[224:227], v[164:167], v[144:147], v[224:227]
    ds_read_b128 v[204:207], v32 offset:0
    v_mfma_f32_16x16x32_bf16 v[228:231], v[168:171], v[144:147], v[228:231]
    ds_read_b128 v[208:211], v32 offset:1024
    v_mfma_f32_16x16x32_bf16 v[232:235], v[172:175], v[144:147], v[232:235]
    ds_read_b128 v[212:215], v33 offset:0
    s_waitcnt vmcnt(1) lgkmcnt(5)
    v_mfma_f32_16x16x32_bf16 v[216:219], v[176:179], v[148:151], v[216:219]
    v_mfma_f32_16x16x32_bf16 v[220:223], v[180:183], v[148:151], v[220:223]
    v_mfma_f32_16x16x32_bf16 v[224:227], v[184:187], v[148:151], v[224:227]
    v_mfma_f32_16x16x32_bf16 v[228:231], v[188:191], v[148:151], v[228:231]
    v_mfma_f32_16x16x32_bf16 v[232:235], v[192:195], v[148:151], v[232:235]
    s_waitcnt vmcnt(0) lgkmcnt(0)
    v_mfma_f32_16x16x32_bf16 v[216:219], v[196:199], v[152:155], v[216:219]
    v_mfma_f32_16x16x32_bf16 v[220:223], v[200:203], v[152:155], v[220:223]
    v_mfma_f32_16x16x32_bf16 v[224:227], v[204:207], v[152:155], v[224:227]
    v_mfma_f32_16x16x32_bf16 v[228:231], v[208:211], v[152:155], v[228:231]
    v_mfma_f32_16x16x32_bf16 v[232:235], v[212:215], v[152:155], v[232:235]
    s_barrier
    s_lshl_b32 s32, s35, 11
    s_mul_i32 s33, s35, 3072
    s_add_u32 s33, s33, 8192
    s_cmp_eq_u32 s34, 0
    s_cselect_b32 s37, s32, s33
    s_cselect_b32 s36, s33, s32
    v_add_u32 v31, s37, v30
    v_add_u32 v32, s36, v30
    ds_write_b128 v31, v[224:227]
    ds_write_b128 v31, v[228:231] offset:1024
    s_cbranch_scc1 L_proj_k2_234094
    ds_write_b128 v31, v[232:235] offset:2048
L_proj_k2_234094:
    s_waitcnt lgkmcnt(0)
    s_barrier
    ds_read_b128 v[156:159], v32 offset:0
    ds_read_b128 v[160:163], v32 offset:1024
    ds_read_b128 v[164:167], v32 offset:2048
    s_waitcnt lgkmcnt(1)
    v_add_f32 v216, v216, v156
    v_add_f32 v217, v217, v157
    v_add_f32 v218, v218, v158
    v_add_f32 v219, v219, v159
    v_add_f32 v220, v220, v160
    v_add_f32 v221, v221, v161
    v_add_f32 v222, v222, v162
    v_add_f32 v223, v223, v163
    v_fma_f32 v4, v216, v16, v4
    v_fma_f32 v5, v217, v17, v5
    v_fma_f32 v6, v218, v18, v6
    v_fma_f32 v7, v219, v19, v7
    v_fma_f32 v8, v220, v20, v8
    v_fma_f32 v9, v221, v21, v9
    v_fma_f32 v10, v222, v22, v10
    v_fma_f32 v11, v223, v23, v11
    v_cvt_pk_bf16_f32 v176, v4, v5
    v_cvt_pk_bf16_f32 v177, v6, v7
    v_cvt_pk_bf16_f32 v178, v8, v9
    v_cvt_pk_bf16_f32 v179, v10, v11
    buffer_store_dwordx4 v[176:179], v38, s[16:19], 0 offen
    s_cmp_lg_u32 s34, 0
    s_cbranch_scc1 L_proj_k1_234093
    s_waitcnt lgkmcnt(0)
    v_add_f32 v232, v232, v164
    v_add_f32 v233, v233, v165
    v_add_f32 v234, v234, v166
    v_add_f32 v235, v235, v167
    v_fma_f32 v12, v232, v24, v12
    v_fma_f32 v13, v233, v25, v13
    v_fma_f32 v14, v234, v26, v14
    v_fma_f32 v15, v235, v27, v15
    v_cvt_pk_bf16_f32 v180, v12, v13
    v_cvt_pk_bf16_f32 v181, v14, v15
    buffer_store_dwordx2 v[180:181], v39, s[16:19], 0 offen
L_proj_k1_234093:
    s_endpgm
L_attn_slow_234048:
    s_waitcnt vmcnt(0) lgkmcnt(0)
    s_mov_b64 exec, s[70:71]
    v_mov_b32 v38, 0
    s_mov_b64 exec, -1
    v_mov_b32 v13, 0xff800000
    s_mov_b32 s59, 0
    s_add_u32 s72, s4, s57
    s_addc_u32 s73, s5, 0
L_slow1_234096:
    global_load_dwordx4 v[46:49], v20, s[72:73] sc1
    global_load_dwordx2 v[62:63], v9, s[72:73] sc1
    s_waitcnt vmcnt(0)
    v_mfma_f32_32x32x16_bf16 v[104:119], v[46:49], v[22:25], 0
    v_mfma_f32_32x32x8bf16_1k v[104:119], v[62:63], v[38:39], v[104:119]
    s_nop 15
    v_max3_f32 v13, v13, v104, v105
    v_max3_f32 v13, v13, v106, v107
    v_max3_f32 v13, v13, v108, v109
    v_max3_f32 v13, v13, v110, v111
    v_max3_f32 v13, v13, v112, v113
    v_max3_f32 v13, v13, v114, v115
    v_max3_f32 v13, v13, v116, v117
    v_max3_f32 v13, v13, v118, v119
    s_add_u32 s72, s72, 10496
    s_addc_u32 s73, s73, 0
    s_add_u32 s59, s59, 1
    s_cmp_lt_u32 s59, 64
    s_cbranch_scc1 L_slow1_234096
    v_mov_b32 v14, v13
    s_nop 1
    v_permlane32_swap_b32 v13, v14
    s_nop 1
    v_max_f32 v15, v13, v14
    v_mov_b32 v136, 0
    v_mov_b32 v137, 0
    v_mov_b32 v138, 0
    v_mov_b32 v139, 0
    v_mov_b32 v140, 0
    v_mov_b32 v141, 0
    v_mov_b32 v142, 0
    v_mov_b32 v143, 0
    v_mov_b32 v144, 0
    v_mov_b32 v145, 0
    v_mov_b32 v146, 0
    v_mov_b32 v147, 0
    v_mov_b32 v148, 0
    v_mov_b32 v149, 0
    v_mov_b32 v150, 0
    v_mov_b32 v151, 0
    s_mov_b32 s59, 0
    s_add_u32 s72, s4, s57
    s_addc_u32 s73, s5, 0
L_slow2_234097:
    global_load_dwordx4 v[46:49], v20, s[72:73] sc1
    global_load_dwordx2 v[62:63], v9, s[72:73] sc1
    global_load_dwordx4 v[70:73], v10, s[72:73] sc1
    global_load_dwordx4 v[86:89], v11, s[72:73] sc1
    s_waitcnt vmcnt(0)
    v_mfma_f32_32x32x16_bf16 v[104:119], v[46:49], v[22:25], 0
    v_mfma_f32_32x32x8bf16_1k v[104:119], v[62:63], v[38:39], v[104:119]
    s_nop 15
    v_sub_f32 v104, v104, v15
    v_sub_f32 v105, v105, v15
    v_sub_f32 v106, v106, v15
    v_sub_f32 v107, v107, v15
    v_sub_f32 v108, v108, v15
    v_sub_f32 v109, v109, v15
    v_sub_f32 v110, v110, v15
    v_sub_f32 v111, v111, v15
    v_sub_f32 v112, v112, v15
    v_sub_f32 v113, v113, v15
    v_sub_f32 v114, v114, v15
    v_sub_f32 v115, v115, v15
    v_sub_f32 v116, v116, v15
    v_sub_f32 v117, v117, v15
    v_sub_f32 v118, v118, v15
    v_sub_f32 v119, v119, v15
    v_exp_f32 v104, v104
    v_exp_f32 v105, v105
    v_exp_f32 v106, v106
    v_exp_f32 v107, v107
    v_exp_f32 v108, v108
    v_exp_f32 v109, v109
    v_exp_f32 v110, v110
    v_exp_f32 v111, v111
    v_exp_f32 v112, v112
    v_exp_f32 v113, v113
    v_exp_f32 v114, v114
    v_exp_f32 v115, v115
    v_exp_f32 v116, v116
    v_exp_f32 v117, v117
    v_exp_f32 v118, v118
    v_exp_f32 v119, v119
    s_nop 1
    v_smfmac_f32_32x32x32_bf16 v[136:151], v[70:73], v[104:111], v12
    v_smfmac_f32_32x32x32_bf16 v[136:151], v[86:89], v[112:119], v12
    s_add_u32 s72, s72, 10496
    s_addc_u32 s73, s73, 0
    s_add_u32 s59, s59, 1
    s_cmp_lt_u32 s59, 64
    s_cbranch_scc1 L_slow2_234097
    s_nop 15
    v_mov_b32 v13, v144
    v_mov_b32 v14, v144
    s_nop 1
    v_permlane32_swap_b32 v13, v14
    s_nop 1
    s_branch L_attn_fin_234047
L_attn_slow_234050:
    s_waitcnt vmcnt(0) lgkmcnt(0)
    s_mov_b64 exec, s[70:71]
    v_mov_b32 v40, 0
    s_mov_b64 exec, -1
    v_mov_b32 v13, 0xff800000
    s_mov_b32 s59, 0
    s_add_u32 s72, s4, s57
    s_addc_u32 s73, s5, 0
L_slow1_234098:
    global_load_dwordx4 v[46:49], v20, s[72:73] sc1
    global_load_dwordx2 v[62:63], v9, s[72:73] sc1
    s_waitcnt vmcnt(0)
    v_mfma_f32_32x32x16_bf16 v[104:119], v[46:49], v[26:29], 0
    v_mfma_f32_32x32x8bf16_1k v[104:119], v[62:63], v[40:41], v[104:119]
    s_nop 15
    v_max3_f32 v13, v13, v104, v105
    v_max3_f32 v13, v13, v106, v107
    v_max3_f32 v13, v13, v108, v109
    v_max3_f32 v13, v13, v110, v111
    v_max3_f32 v13, v13, v112, v113
    v_max3_f32 v13, v13, v114, v115
    v_max3_f32 v13, v13, v116, v117
    v_max3_f32 v13, v13, v118, v119
    s_add_u32 s72, s72, 10496
    s_addc_u32 s73, s73, 0
    s_add_u32 s59, s59, 1
    s_cmp_lt_u32 s59, 64
    s_cbranch_scc1 L_slow1_234098
    v_mov_b32 v14, v13
    s_nop 1
    v_permlane32_swap_b32 v13, v14
    s_nop 1
    v_max_f32 v15, v13, v14
    v_mov_b32 v152, 0
    v_mov_b32 v153, 0
    v_mov_b32 v154, 0
    v_mov_b32 v155, 0
    v_mov_b32 v156, 0
    v_mov_b32 v157, 0
    v_mov_b32 v158, 0
    v_mov_b32 v159, 0
    v_mov_b32 v160, 0
    v_mov_b32 v161, 0
    v_mov_b32 v162, 0
    v_mov_b32 v163, 0
    v_mov_b32 v164, 0
    v_mov_b32 v165, 0
    v_mov_b32 v166, 0
    v_mov_b32 v167, 0
    s_mov_b32 s59, 0
    s_add_u32 s72, s4, s57
    s_addc_u32 s73, s5, 0
L_slow2_234099:
    global_load_dwordx4 v[46:49], v20, s[72:73] sc1
    global_load_dwordx2 v[62:63], v9, s[72:73] sc1
    global_load_dwordx4 v[70:73], v10, s[72:73] sc1
    global_load_dwordx4 v[86:89], v11, s[72:73] sc1
    s_waitcnt vmcnt(0)
    v_mfma_f32_32x32x16_bf16 v[104:119], v[46:49], v[26:29], 0
    v_mfma_f32_32x32x8bf16_1k v[104:119], v[62:63], v[40:41], v[104:119]
    s_nop 15
    v_sub_f32 v104, v104, v15
    v_sub_f32 v105, v105, v15
    v_sub_f32 v106, v106, v15
    v_sub_f32 v107, v107, v15
    v_sub_f32 v108, v108, v15
    v_sub_f32 v109, v109, v15
    v_sub_f32 v110, v110, v15
    v_sub_f32 v111, v111, v15
    v_sub_f32 v112, v112, v15
    v_sub_f32 v113, v113, v15
    v_sub_f32 v114, v114, v15
    v_sub_f32 v115, v115, v15
    v_sub_f32 v116, v116, v15
    v_sub_f32 v117, v117, v15
    v_sub_f32 v118, v118, v15
    v_sub_f32 v119, v119, v15
    v_exp_f32 v104, v104
    v_exp_f32 v105, v105
    v_exp_f32 v106, v106
    v_exp_f32 v107, v107
    v_exp_f32 v108, v108
    v_exp_f32 v109, v109
    v_exp_f32 v110, v110
    v_exp_f32 v111, v111
    v_exp_f32 v112, v112
    v_exp_f32 v113, v113
    v_exp_f32 v114, v114
    v_exp_f32 v115, v115
    v_exp_f32 v116, v116
    v_exp_f32 v117, v117
    v_exp_f32 v118, v118
    v_exp_f32 v119, v119
    s_nop 1
    v_smfmac_f32_32x32x32_bf16 v[152:167], v[70:73], v[104:111], v12
    v_smfmac_f32_32x32x32_bf16 v[152:167], v[86:89], v[112:119], v12
    s_add_u32 s72, s72, 10496
    s_addc_u32 s73, s73, 0
    s_add_u32 s59, s59, 1
    s_cmp_lt_u32 s59, 64
    s_cbranch_scc1 L_slow2_234099
    s_nop 15
    v_mov_b32 v13, v160
    v_mov_b32 v14, v160
    s_nop 1
    v_permlane32_swap_b32 v13, v14
    s_nop 1
    s_branch L_attn_fin_234049
L_end_adaLN_cond__mha_block__glu_gated_glu__prompt_kernel:
    s_endpgm
.section .rodata,"a"
.p2align 6
.amdhsa_kernel adaLN_cond__mha_block__glu_gated_glu__prompt_kernel
  .amdhsa_next_free_vgpr 256
  .amdhsa_next_free_sgpr 102
  .amdhsa_accum_offset 256
  .amdhsa_group_segment_fixed_size 0
  .amdhsa_kernarg_size 96
  .amdhsa_user_sgpr_count 2
  .amdhsa_user_sgpr_kernarg_segment_ptr 1
  .amdhsa_system_sgpr_workgroup_id_x 1
.end_amdhsa_kernel
```
